```python
import torch

def _softmax(x, axis=-1):
    return torch.softmax(x, dim=axis)
def _gelu(x):
    return torch.nn.functional.gelu(x, approximate="tanh")
def _silu(x):
    return torch.nn.functional.silu(x)
def _sigmoid(x):
    return torch.sigmoid(x)
def _layernorm(x, axis=-1, eps=1e-5):
    m = x.mean(dim=axis, keepdim=True)
    v = x.var(dim=axis, keepdim=True, unbiased=False)
    return (x - m) / torch.sqrt(v + eps)
def _scatter_add(tgt, idx, src, axis=0):
    return tgt.clone().index_add_(axis, idx, src)
def _segment_sum(src, seg, n):
    out = torch.zeros((n,) + src.shape[1:], dtype=src.dtype)
    return out.index_add_(0, seg, src)
def _pad(x, pw):
    flat = tuple(v for pair in reversed(pw) for v in pair)
    return torch.nn.functional.pad(x, flat)

kernel_name = 'gated_mix__gqa_block_cached__glu_gated_glu__decode'

def setup_inputs():

    _w = (lambda a: (lambda t: t.to(torch.bfloat16) if t.is_floating_point() else t)(torch.as_tensor(a)))
    def _A_setup():
        B, Sq, D = 4, 1, 512
        Hq, Hkv, Sk, Dh = 32, 32, 4096, 128
        assert Hq % Hkv == 0, (Hq, Hkv)
        return {
            "x": _w((lambda *s: torch.randn(*s, dtype=torch.bfloat16) * 0.05)(B, Sq, D)),
            "k_cache": _w((lambda *s: torch.randn(*s, dtype=torch.bfloat16) * 6.4)(B, Hkv, Sk, Dh)),
            "v_cache": _w((lambda *s: torch.randn(*s, dtype=torch.bfloat16) * 0.4)(B, Hkv, Sk, Dh)),
            "wq": _w((lambda *s: torch.randn(*s, dtype=torch.bfloat16) * 6.4)(D, Hq * Dh) * (D ** -0.5)),
            "wo": _w((lambda *s: torch.randn(*s, dtype=torch.bfloat16) * 0.4)(Hq * Dh, D) * ((Hq * Dh) ** -0.5)),
        }
    _A_in = _A_setup()

    def _B_setup():
        B, S, D, F = 4, 1, 512, 1376
        return {
            "x": _w((lambda *s: torch.randn(*s, dtype=torch.bfloat16) * 0.05)(B, S, D)),
            "w_gate": _w((lambda *s: torch.randn(*s, dtype=torch.bfloat16) * 0.4)(D, F)),
            "w_up": _w((lambda *s: torch.randn(*s, dtype=torch.bfloat16) * 0.05)(D, F)),
            "w_down": _w((lambda *s: torch.randn(*s, dtype=torch.bfloat16) * 0.05)(F, D)),
        }
    _B_in = _B_setup()

    return {
        "A_x": _A_in["x"],
        "A_k_cache": _A_in["k_cache"],
        "A_v_cache": _A_in["v_cache"],
        "A_wq": _A_in["wq"],
        "A_wo": _A_in["wo"],
        "B_x": _B_in["x"],
        "B_w_gate": _B_in["w_gate"],
        "B_w_up": _B_in["w_up"],
        "B_w_down": _B_in["w_down"],
        "gate_w": _w((lambda *s: torch.randn(*s, dtype=torch.bfloat16) * 0.05)(512) * 16.0),
    }

def reference(A_x, A_k_cache, A_v_cache, A_wq, A_wo, B_x, B_w_gate, B_w_up, B_w_down, gate_w):
    def _A_ref(x, k_cache, v_cache, wq, wo):
        B, Sq, D = x.shape
        Hq, Dh = 32, 128
        Hkv = k_cache.shape[1]
        rep = Hq // Hkv
        q = (lambda x, *d: x.permute(*d))((x @ wq).reshape(B, Sq, Hq, Dh), 0, 2, 1, 3)
        k = (lambda x, n, axis: torch.repeat_interleave(x, n, dim=axis))(k_cache, rep, axis=1)
        v = (lambda x, n, axis: torch.repeat_interleave(x, n, dim=axis))(v_cache, rep, axis=1)
        scores = torch.einsum("bhqd,bhkd->bhqk", q, k) * (Dh ** -0.5)
        p = _softmax(scores, axis=-1)
        o = torch.einsum("bhqk,bhkd->bhqd", p, v)
        return (lambda x, *d: x.permute(*d))(o, 0, 2, 1, 3).reshape(B, Sq, Hq * Dh) @ wo

    def _B_ref(x, w_gate, w_up, w_down):
        g = torch.einsum("bsd,df->bsf", x, w_gate)
        u = torch.einsum("bsd,df->bsf", x, w_up)
        h = _sigmoid(g) * u
        return torch.einsum("bsf,fd->bsd", h, w_down)

    x = A_x
    g = _sigmoid((x * gate_w).sum(-1, keepdims=True))
    a = _A_ref(x, A_k_cache, A_v_cache, A_wq, A_wo)
    b = _B_ref(x, B_w_gate, B_w_up, B_w_down)
    return g * a + (1 - g) * b
```

```asm
; @launch grid=(256,1,1) block=(512,1,1) lds=65536
.amdgcn_target "amdgcn-amd-amdhsa--gfx950"
.text
.globl gated_mix__gqa_block_cached__glu_gated_glu__decode_kernel
.p2align 8
.type gated_mix__gqa_block_cached__glu_gated_glu__decode_kernel,@function
gated_mix__gqa_block_cached__glu_gated_glu__decode_kernel:
    s_cmp_ge_u32 s2, 256
    s_cbranch_scc1 L_exit
    s_load_dwordx8 s[4:11], s[0:1], 0
    s_load_dwordx2 s[12:13], s[0:1], 32
    s_load_dwordx8 s[16:23], s[0:1], 48
    s_load_dwordx2 s[24:25], s[0:1], 80
    s_load_dwordx2 s[28:29], s[0:1], 96
    s_mov_b32 s3, s2
    v_and_b32 v1, 63, v0
    v_lshrrev_b32 v0, 6, v0
    v_lshrrev_b32 v2, 4, v1
    v_and_b32 v3, 15, v1
    s_mov_b32 s80, 0x22222222
    s_mov_b32 s81, 0x22222222
    s_mov_b32 s82, 0x44444444
    s_mov_b32 s83, 0x44444444
    s_mov_b32 s84, 0x88888888
    s_mov_b32 s85, 0x88888888
    s_mov_b32 s86, 0xf000f
    s_mov_b32 s87, 0xf000f
    s_mov_b32 s88, 0xf000f0
    s_mov_b32 s89, 0xf000f0
    s_mov_b32 s90, 0xf000f00
    s_mov_b32 s91, 0xf000f00
    s_mov_b32 s92, 0xf000f000
    s_mov_b32 s93, 0xf000f000
    v_mov_b32 v12, 0xffff
    v_mov_b32 v13, 0xffff0000
    v_and_b32 v14, 2, v3
    v_cmp_ne_u32 vcc, 0, v14
    s_nop 1
    v_cndmask_b32 v12, v12, v13, vcc
    v_cndmask_b32 v44, 0, v12, s[86:87]
    v_cndmask_b32 v45, 0, v12, s[88:89]
    v_cndmask_b32 v46, 0, v12, s[90:91]
    v_cndmask_b32 v47, 0, v12, s[92:93]
    v_bfe_u32 v12, v1, 2, 2
    v_lshlrev_b32 v4, 14, v12
    v_lshl_add_u32 v4, v2, 6, v4
    v_and_b32 v12, 3, v1
    v_lshl_add_u32 v4, v12, 4, v4
    v_lshlrev_b32 v5, 4, v1
    s_and_b32 s94, s3, 7
    s_lshr_b32 s96, s3, 3
    s_and_b32 s95, s96, 3
    s_lshl_b32 s95, s95, 1
    s_add_u32 s95, s95, 1
    s_ff1_i32_b32 s97, s95
    s_lshr_b32 s99, s94, s97
    s_and_b32 s99, s99, 1
    s_mul_i32 s95, s95, s99
    s_xor_b32 s94, s94, s95
    s_bfm_b32 s95, s97, 0
    s_and_b32 s98, s94, s95
    s_lshr_b32 s94, s94, 1
    s_andn2_b32 s94, s94, s95
    s_or_b32 s98, s98, s94
    s_lshl_b32 s97, s98, 5
    s_add_u32 s97, s97, s96
    s_mul_i32 s101, s97, 128
    s_add_u32 s101, s101, 1060864
    s_lshl_b32 s97, s97, 20
    s_mul_i32 s66, s99, 255
    s_lshl_b32 s67, s99, 4
    s_lshl_b32 s67, 1, s67
    s_lshr_b32 s30, s3, 6
    s_and_b32 s31, s3, 63
    v_mov_b32 v12, 0
    v_mov_b32 v13, 0
    v_mov_b32 v14, 0
    v_mov_b32 v15, 0
    s_mov_b64 exec, 1
    ds_write_b128 v14, v[12:15] offset:8256
    s_mov_b64 exec, -1
    v_readfirstlane_b32 s100, v0
    s_cmp_lg_u32 s100, 1
    s_cselect_b32 s64, 1, 0
    v_lshrrev_b32 v60, 3, v1
    v_bfe_u32 v12, v1, 4, 1
    v_lshlrev_b32 v12, 1, v12
    v_and_b32 v13, 7, v1
    v_xor_b32 v12, v12, v13
    v_lshlrev_b32 v52, 4, v12
    v_xor_b32 v53, 64, v52
    s_movk_i32 s95, 8192
    v_mad_u32_u24 v54, v60, s95, v52
    v_mad_u32_u24 v55, v60, s95, v53
    v_and_b32 v12, 3, v3
    v_lshlrev_b32 v12, 10, v12
    v_lshl_add_u32 v12, v2, 4, v12
    s_lshl_b32 s100, s98, 8
    s_lshl_b32 s94, s98, 20
    s_lshl_b32 s95, s96, 8
    s_add_u32 s94, s94, s95
    s_lshl_b32 s95, s99, 7
    s_add_u32 s94, s94, s95
    s_mov_b32 m0, 16384
    s_mov_b32 s50, 4096
    s_mov_b32 s51, 0x00020000
    s_mov_b32 s42, 4194304
    s_mov_b32 s43, 0x00020000
    s_mov_b32 s95, 65536
    s_cmp_lg_u32 s64, 0
    s_waitcnt lgkmcnt(0)
    s_mov_b32 s48, s4
    s_mov_b32 s49, s5
    s_mov_b32 s40, s10
    s_mov_b32 s41, s11
    s_cbranch_scc1 L_common
    s_setprio 3
    s_and_b32 s49, s49, 0xffff
    s_and_b32 s41, s41, 0xffff
    buffer_load_dwordx4 v[20:23], v12, s[48:51], s100 offen offset:0
    buffer_load_dwordx4 v[24:27], v12, s[48:51], s100 offen offset:64
    buffer_load_dwordx4 v[28:31], v12, s[48:51], s100 offen offset:128
    buffer_load_dwordx4 v[32:35], v12, s[48:51], s100 offen offset:192
L_ql:
    buffer_load_dwordx4 v54, s[40:43], s94 offen nt lds
    s_add_u32 m0, m0, 1024
    s_add_u32 s94, s94, s95
    buffer_load_dwordx4 v55, s[40:43], s94 offen nt lds
    s_add_u32 m0, m0, 1024
    s_add_u32 s94, s94, s95
    s_cmp_lt_u32 m0, 32768
    s_cbranch_scc1 L_ql
    s_barrier
L_common:
    s_waitcnt lgkmcnt(0)
    s_load_dword s26, s[28:29], 0
    s_add_u32 s32, s6, s97
    s_addc_u32 s33, s7, 0
    s_and_b32 s33, s33, 0xffff
    s_mov_b32 s34, 1048576
    s_mov_b32 s35, 0x00020000
    s_add_u32 s36, s8, s97
    s_addc_u32 s37, s9, 0
    s_and_b32 s37, s37, 0xffff
    s_mov_b32 s38, 1048576
    s_mov_b32 s39, 0x00020000
    s_mov_b32 s48, s4
    s_and_b32 s49, s5, 0xffff
    s_mov_b32 s50, 4096
    s_mov_b32 s51, 0x00020000
    s_mov_b32 s40, s10
    s_and_b32 s41, s11, 0xffff
    s_mov_b32 s42, 4194304
    s_mov_b32 s43, 0x00020000
    s_mov_b32 s44, s12
    s_and_b32 s45, s13, 0xffff
    s_mov_b32 s46, 4194304
    s_mov_b32 s47, 0x00020000
    s_mov_b32 s52, s28
    s_and_b32 s53, s29, 0xffff
    s_mov_b32 s54, 1077248
    s_mov_b32 s55, 0x00020000
    s_mov_b32 s56, s24
    s_and_b32 s57, s25, 0xffff
    s_mov_b32 s58, 4096
    s_mov_b32 s59, 0x00020000
    s_mov_b32 s60, s22
    s_and_b32 s61, s23, 0xffff
    s_mov_b32 s62, 1024
    s_mov_b32 s63, 0x00020000
    s_mov_b32 s68, s16
    s_and_b32 s69, s17, 0xffff
    s_mov_b32 s70, 1409024
    s_mov_b32 s71, 0x00020000
    s_mov_b32 s72, s18
    s_and_b32 s73, s19, 0xffff
    s_mov_b32 s74, 1409024
    s_mov_b32 s75, 0x00020000
    s_mov_b32 s76, s20
    s_and_b32 s77, s21, 0xffff
    s_mov_b32 s78, 1409024
    s_mov_b32 s79, 0x00020000
    v_readfirstlane_b32 s16, v0
    v_lshlrev_b32 v0, 14, v2
    v_lshl_add_u32 v0, v3, 4, v0
    s_mov_b32 s17, s98
    s_mov_b32 s18, s96
    s_mov_b32 s20, 0x3fb8aa3b
    s_mov_b32 s21, 0
    s_bitcmp1_b32 s3, 0
    s_cselect_b32 s68, s72, s68
    s_cselect_b32 s69, s73, s69
    s_lshl_b32 s24, s98, 1
    s_add_u32 s24, s24, s99
    s_lshl_b32 s25, s96, 3
    s_add_u32 s25, s25, s24
    v_mov_b32 v17, 1
    s_cmp_eq_u32 s16, 1
    s_cbranch_scc1 L_qp
    s_barrier
    s_cmp_eq_u32 s16, 2
    s_cbranch_scc1 L_svc
    s_mov_b32 s97, s16
    s_cmp_gt_u32 s16, 1
    s_subb_u32 s97, s97, 0
    s_cmp_gt_u32 s16, 2
    s_subb_u32 s97, s97, 0
    s_xor_b32 s5, s97, s66
    s_and_b32 s94, s5, 0x1
    s_lshl_b32 s94, s94, 13
    s_and_b32 s6, s5, 0x2
    s_lshl_b32 s6, s6, 10
    s_or_b32 s94, s94, s6
    s_and_b32 s6, s5, 0x4
    s_lshl_b32 s6, s6, 8
    s_or_b32 s94, s94, s6
    s_and_b32 s6, s5, 0x8
    s_lshl_b32 s6, s6, 13
    s_or_b32 s94, s94, s6
    s_and_b32 s6, s5, 0x10
    s_lshl_b32 s6, s6, 8
    s_or_b32 s94, s94, s6
    s_and_b32 s6, s5, 0xe0
    s_lshl_b32 s6, s6, 12
    s_or_b32 s94, s94, s6
    buffer_load_dwordx4 v[128:131], v4, s[32:35], s94 offen offset:0 nt
    buffer_load_dwordx4 v[132:135], v4, s[32:35], s94 offen offset:256 nt
    buffer_load_dwordx4 v[136:139], v4, s[32:35], s94 offen offset:512 nt
    buffer_load_dwordx4 v[140:143], v4, s[32:35], s94 offen offset:768 nt
    buffer_load_dwordx4 v[144:147], v0, s[36:39], s94 offen offset:0 nt
    buffer_load_dwordx4 v[148:151], v0, s[36:39], s94 offen offset:256 nt
    buffer_load_dwordx4 v[152:155], v0, s[36:39], s94 offen offset:512 nt
    buffer_load_dwordx4 v[156:159], v0, s[36:39], s94 offen offset:768 nt
    s_add_u32 s97, s97, 6
    s_xor_b32 s5, s97, s66
    s_and_b32 s94, s5, 0x1
    s_lshl_b32 s94, s94, 13
    s_and_b32 s6, s5, 0x2
    s_lshl_b32 s6, s6, 10
    s_or_b32 s94, s94, s6
    s_and_b32 s6, s5, 0x4
    s_lshl_b32 s6, s6, 8
    s_or_b32 s94, s94, s6
    s_and_b32 s6, s5, 0x8
    s_lshl_b32 s6, s6, 13
    s_or_b32 s94, s94, s6
    s_and_b32 s6, s5, 0x10
    s_lshl_b32 s6, s6, 8
    s_or_b32 s94, s94, s6
    s_and_b32 s6, s5, 0xe0
    s_lshl_b32 s6, s6, 12
    s_or_b32 s94, s94, s6
    s_waitcnt vmcnt(7)
    buffer_load_dwordx4 v[160:163], v4, s[32:35], s94 offen offset:0 nt
    s_waitcnt vmcnt(7)
    buffer_load_dwordx4 v[164:167], v4, s[32:35], s94 offen offset:256 nt
    s_waitcnt vmcnt(7)
    buffer_load_dwordx4 v[168:171], v4, s[32:35], s94 offen offset:512 nt
    s_waitcnt vmcnt(7)
    buffer_load_dwordx4 v[172:175], v4, s[32:35], s94 offen offset:768 nt
    s_waitcnt vmcnt(7)
    buffer_load_dwordx4 v[176:179], v0, s[36:39], s94 offen offset:0 nt
    s_waitcnt vmcnt(7)
    buffer_load_dwordx4 v[180:183], v0, s[36:39], s94 offen offset:256 nt
    s_waitcnt vmcnt(7)
    buffer_load_dwordx4 v[184:187], v0, s[36:39], s94 offen offset:512 nt
    s_waitcnt vmcnt(7)
    buffer_load_dwordx4 v[188:191], v0, s[36:39], s94 offen offset:768 nt
    s_add_u32 s97, s97, 6
    s_xor_b32 s5, s97, s66
    s_and_b32 s94, s5, 0x1
    s_lshl_b32 s94, s94, 13
    s_and_b32 s6, s5, 0x2
    s_lshl_b32 s6, s6, 10
    s_or_b32 s94, s94, s6
    s_and_b32 s6, s5, 0x4
    s_lshl_b32 s6, s6, 8
    s_or_b32 s94, s94, s6
    s_and_b32 s6, s5, 0x8
    s_lshl_b32 s6, s6, 13
    s_or_b32 s94, s94, s6
    s_and_b32 s6, s5, 0x10
    s_lshl_b32 s6, s6, 8
    s_or_b32 s94, s94, s6
    s_and_b32 s6, s5, 0xe0
    s_lshl_b32 s6, s6, 12
    s_or_b32 s94, s94, s6
    s_waitcnt vmcnt(7)
    buffer_load_dwordx4 v[64:67], v4, s[32:35], s94 offen offset:0 nt
    s_waitcnt vmcnt(7)
    buffer_load_dwordx4 v[68:71], v4, s[32:35], s94 offen offset:256 nt
    s_waitcnt vmcnt(7)
    buffer_load_dwordx4 v[72:75], v4, s[32:35], s94 offen offset:512 nt
    s_waitcnt vmcnt(7)
    buffer_load_dwordx4 v[76:79], v4, s[32:35], s94 offen offset:768 nt
    s_waitcnt vmcnt(7)
    buffer_load_dwordx4 v[80:83], v0, s[36:39], s94 offen offset:0 nt
    s_waitcnt vmcnt(7)
    buffer_load_dwordx4 v[84:87], v0, s[36:39], s94 offen offset:256 nt
    s_waitcnt vmcnt(7)
    buffer_load_dwordx4 v[88:91], v0, s[36:39], s94 offen offset:512 nt
    s_waitcnt vmcnt(7)
    buffer_load_dwordx4 v[92:95], v0, s[36:39], s94 offen offset:768 nt
    s_add_u32 s97, s97, 6
    s_xor_b32 s5, s97, s66
    s_and_b32 s94, s5, 0x1
    s_lshl_b32 s94, s94, 13
    s_and_b32 s6, s5, 0x2
    s_lshl_b32 s6, s6, 10
    s_or_b32 s94, s94, s6
    s_and_b32 s6, s5, 0x4
    s_lshl_b32 s6, s6, 8
    s_or_b32 s94, s94, s6
    s_and_b32 s6, s5, 0x8
    s_lshl_b32 s6, s6, 13
    s_or_b32 s94, s94, s6
    s_and_b32 s6, s5, 0x10
    s_lshl_b32 s6, s6, 8
    s_or_b32 s94, s94, s6
    s_and_b32 s6, s5, 0xe0
    s_lshl_b32 s6, s6, 12
    s_or_b32 s94, s94, s6
    s_waitcnt vmcnt(7)
    buffer_load_dwordx4 v[96:99], v4, s[32:35], s94 offen offset:0 nt
    s_waitcnt vmcnt(7)
    buffer_load_dwordx4 v[100:103], v4, s[32:35], s94 offen offset:256 nt
    s_waitcnt vmcnt(7)
    buffer_load_dwordx4 v[104:107], v4, s[32:35], s94 offen offset:512 nt
    s_waitcnt vmcnt(7)
    buffer_load_dwordx4 v[108:111], v4, s[32:35], s94 offen offset:768 nt
    s_waitcnt vmcnt(7)
    buffer_load_dwordx4 v[112:115], v0, s[36:39], s94 offen offset:0 nt
    s_waitcnt vmcnt(7)
    buffer_load_dwordx4 v[116:119], v0, s[36:39], s94 offen offset:256 nt
    s_waitcnt vmcnt(7)
    buffer_load_dwordx4 v[120:123], v0, s[36:39], s94 offen offset:512 nt
    s_waitcnt vmcnt(7)
    buffer_load_dwordx4 v[124:127], v0, s[36:39], s94 offen offset:768 nt
    v_mov_b32 v12, 0
L_gq:
    ds_read_b64 v[14:15], v12 offset:8256
    s_waitcnt lgkmcnt(0)
    v_readfirstlane_b32 s97, v15
    v_readfirstlane_b32 s98, v14
    s_cmp_eq_u32 s97, 0
    s_cbranch_scc0 L_gdq
    s_sleep 1
    s_branch L_gq
L_gdq:
L_qgo:
    v_and_b32 v12, 3, v3
    v_lshl_add_u32 v12, v2, 2, v12
    v_lshlrev_b32 v12, 4, v12
    ds_read_b128 v[40:43], v12 offset:0
    s_mov_b64 exec, 1
    ds_add_rtn_u32 v7, v5, v17 offset:8256
    s_mov_b64 exec, -1
    v_lshlrev_b32 v12, 5, v3
    v_lshl_add_u32 v12, v2, 3, v12
    s_lshl_b32 s97, s16, 9
    s_add_u32 s97, s97, 4096
    v_add_u32 v9, s97, v12
    v_mov_b32 v10, 0xff800000
    v_mov_b32 v18, 0
    v_mov_b32 v11, 0
    v_mov_b32 v20, 0
    v_mov_b32 v21, 0
    v_mov_b32 v22, 0
    v_mov_b32 v23, 0
    s_waitcnt lgkmcnt(1)
    v_cndmask_b32 v48, 0, v40, s[86:87]
    v_cndmask_b32 v49, 0, v41, s[86:87]
    v_cndmask_b32 v50, 0, v42, s[86:87]
    v_cndmask_b32 v51, 0, v43, s[86:87]
    v_cndmask_b32 v52, 0, v40, s[88:89]
    v_cndmask_b32 v53, 0, v41, s[88:89]
    v_cndmask_b32 v54, 0, v42, s[88:89]
    v_cndmask_b32 v55, 0, v43, s[88:89]
    v_cndmask_b32 v56, 0, v40, s[90:91]
    v_cndmask_b32 v57, 0, v41, s[90:91]
    v_cndmask_b32 v58, 0, v42, s[90:91]
    v_cndmask_b32 v59, 0, v43, s[90:91]
    v_cndmask_b32 v60, 0, v40, s[92:93]
    v_cndmask_b32 v61, 0, v41, s[92:93]
    v_cndmask_b32 v62, 0, v42, s[92:93]
    v_cndmask_b32 v63, 0, v43, s[92:93]
    s_sub_u32 s23, s16, 1
    s_mul_i32 s27, s26, 0x9e3779b1
    s_add_u32 s27, s27, 0x7f4a7c15
    s_lshr_b32 s97, 0x3, s16
    s_bitcmp1_b32 s97, 0
    s_cselect_b32 s22, 0, 2
    s_mov_b32 s95, 104
    s_cselect_b32 s95, 106, s95
L_loop:
    s_waitcnt lgkmcnt(0)
    v_readfirstlane_b32 s96, v7
    s_cmp_ge_u32 s96, s95
    s_cbranch_scc1 L_pre0
    s_mov_b64 exec, 1
    ds_add_rtn_u32 v7, v5, v17 offset:8256
    s_mov_b64 exec, -1
L_preb0:
    s_xor_b32 s5, s96, s66
    s_and_b32 s94, s5, 0x1
    s_lshl_b32 s94, s94, 13
    s_and_b32 s6, s5, 0x2
    s_lshl_b32 s6, s6, 10
    s_or_b32 s94, s94, s6
    s_and_b32 s6, s5, 0x4
    s_lshl_b32 s6, s6, 8
    s_or_b32 s94, s94, s6
    s_and_b32 s6, s5, 0x8
    s_lshl_b32 s6, s6, 13
    s_or_b32 s94, s94, s6
    s_and_b32 s6, s5, 0x10
    s_lshl_b32 s6, s6, 8
    s_or_b32 s94, s94, s6
    s_and_b32 s6, s5, 0xe0
    s_lshl_b32 s6, s6, 12
    s_or_b32 s94, s94, s6
    s_waitcnt vmcnt(15)
    v_mfma_f32_16x16x32_bf16 v[36:39], v[64:67], v[48:51], 0
    buffer_load_dwordx4 v[64:67], v4, s[32:35], s94 offen offset:0 nt
    s_waitcnt vmcnt(15)
    v_mfma_f32_16x16x32_bf16 v[36:39], v[68:71], v[52:55], v[36:39]
    buffer_load_dwordx4 v[68:71], v4, s[32:35], s94 offen offset:256 nt
    s_waitcnt vmcnt(15)
    v_mfma_f32_16x16x32_bf16 v[36:39], v[72:75], v[56:59], v[36:39]
    buffer_load_dwordx4 v[72:75], v4, s[32:35], s94 offen offset:512 nt
    s_waitcnt vmcnt(15)
    v_mfma_f32_16x16x32_bf16 v[36:39], v[76:79], v[60:63], v[36:39]
    buffer_load_dwordx4 v[76:79], v4, s[32:35], s94 offen offset:768 nt
    s_nop 6
    v_cndmask_b32 v16, v36, v37, s[80:81]
    v_cndmask_b32 v16, v16, v38, s[82:83]
    v_cndmask_b32 v16, v16, v39, s[84:85]
    s_nop 1
    v_add_f32_dpp v12, v16, v16 quad_perm:[1,0,3,2] row_mask:0xf bank_mask:0xf
    s_nop 1
    v_add_f32_dpp v16, v12, v12 quad_perm:[2,3,0,1] row_mask:0xf bank_mask:0xf
    v_cvt_pk_bf16_f32 v16, v16, v16
    v_and_b32 v16, 0xffff0000, v16
    v_mul_f32 v16, 0x3db504f3, v16
    v_cvt_pk_bf16_f32 v16, v16, v16
    v_and_b32 v16, 0xffff0000, v16
    v_cmp_gt_f32 vcc, v16, v10
    s_cbranch_vccnz L_resc_0
L_back_0:
    v_fma_f32 v12, v16, s20, -v18
    v_exp_f32 v12, v12
    s_nop 0
    v_cvt_pk_bf16_f32 v19, v12, v12
    v_add_f32 v11, v11, v12
    s_nop 0
    v_and_b32_dpp v40, v19, v44 row_newbcast:0 row_mask:0xf bank_mask:0xf
    v_and_b32_dpp v41, v19, v45 row_newbcast:0 row_mask:0xf bank_mask:0xf
    v_and_b32_dpp v42, v19, v46 row_newbcast:0 row_mask:0xf bank_mask:0xf
    v_and_b32_dpp v43, v19, v47 row_newbcast:0 row_mask:0xf bank_mask:0xf
    s_waitcnt vmcnt(15)
    s_nop 0
    v_mfma_f32_16x16x32_bf16 v[20:23], v[40:43], v[80:83], v[20:23]
    buffer_load_dwordx4 v[80:83], v0, s[36:39], s94 offen offset:0 nt
    v_and_b32_dpp v40, v19, v44 row_newbcast:4 row_mask:0xf bank_mask:0xf
    v_and_b32_dpp v41, v19, v45 row_newbcast:4 row_mask:0xf bank_mask:0xf
    v_and_b32_dpp v42, v19, v46 row_newbcast:4 row_mask:0xf bank_mask:0xf
    v_and_b32_dpp v43, v19, v47 row_newbcast:4 row_mask:0xf bank_mask:0xf
    s_waitcnt vmcnt(15)
    s_nop 0
    v_mfma_f32_16x16x32_bf16 v[20:23], v[40:43], v[84:87], v[20:23]
    buffer_load_dwordx4 v[84:87], v0, s[36:39], s94 offen offset:256 nt
    v_and_b32_dpp v40, v19, v44 row_newbcast:8 row_mask:0xf bank_mask:0xf
    v_and_b32_dpp v41, v19, v45 row_newbcast:8 row_mask:0xf bank_mask:0xf
    v_and_b32_dpp v42, v19, v46 row_newbcast:8 row_mask:0xf bank_mask:0xf
    v_and_b32_dpp v43, v19, v47 row_newbcast:8 row_mask:0xf bank_mask:0xf
    s_waitcnt vmcnt(15)
    s_nop 0
    v_mfma_f32_16x16x32_bf16 v[20:23], v[40:43], v[88:91], v[20:23]
    buffer_load_dwordx4 v[88:91], v0, s[36:39], s94 offen offset:512 nt
    v_and_b32_dpp v40, v19, v44 row_newbcast:12 row_mask:0xf bank_mask:0xf
    v_and_b32_dpp v41, v19, v45 row_newbcast:12 row_mask:0xf bank_mask:0xf
    v_and_b32_dpp v42, v19, v46 row_newbcast:12 row_mask:0xf bank_mask:0xf
    v_and_b32_dpp v43, v19, v47 row_newbcast:12 row_mask:0xf bank_mask:0xf
    s_waitcnt vmcnt(15)
    s_nop 0
    v_mfma_f32_16x16x32_bf16 v[20:23], v[40:43], v[92:95], v[20:23]
    buffer_load_dwordx4 v[92:95], v0, s[36:39], s94 offen offset:768 nt
    s_waitcnt lgkmcnt(0)
    v_readfirstlane_b32 s96, v7
    s_cmp_ge_u32 s96, s95
    s_cbranch_scc1 L_pre1
    s_mov_b64 exec, 1
    ds_add_rtn_u32 v7, v5, v17 offset:8256
    s_mov_b64 exec, -1
L_preb1:
    s_xor_b32 s5, s96, s66
    s_and_b32 s94, s5, 0x1
    s_lshl_b32 s94, s94, 13
    s_and_b32 s6, s5, 0x2
    s_lshl_b32 s6, s6, 10
    s_or_b32 s94, s94, s6
    s_and_b32 s6, s5, 0x4
    s_lshl_b32 s6, s6, 8
    s_or_b32 s94, s94, s6
    s_and_b32 s6, s5, 0x8
    s_lshl_b32 s6, s6, 13
    s_or_b32 s94, s94, s6
    s_and_b32 s6, s5, 0x10
    s_lshl_b32 s6, s6, 8
    s_or_b32 s94, s94, s6
    s_and_b32 s6, s5, 0xe0
    s_lshl_b32 s6, s6, 12
    s_or_b32 s94, s94, s6
    s_waitcnt vmcnt(15)
    v_mfma_f32_16x16x32_bf16 v[36:39], v[96:99], v[48:51], 0
    buffer_load_dwordx4 v[96:99], v4, s[32:35], s94 offen offset:0 nt
    s_waitcnt vmcnt(15)
    v_mfma_f32_16x16x32_bf16 v[36:39], v[100:103], v[52:55], v[36:39]
    buffer_load_dwordx4 v[100:103], v4, s[32:35], s94 offen offset:256 nt
    s_waitcnt vmcnt(15)
    v_mfma_f32_16x16x32_bf16 v[36:39], v[104:107], v[56:59], v[36:39]
    buffer_load_dwordx4 v[104:107], v4, s[32:35], s94 offen offset:512 nt
    s_waitcnt vmcnt(15)
    v_mfma_f32_16x16x32_bf16 v[36:39], v[108:111], v[60:63], v[36:39]
    buffer_load_dwordx4 v[108:111], v4, s[32:35], s94 offen offset:768 nt
    s_nop 6
    v_cndmask_b32 v16, v36, v37, s[80:81]
    v_cndmask_b32 v16, v16, v38, s[82:83]
    v_cndmask_b32 v16, v16, v39, s[84:85]
    s_nop 1
    v_add_f32_dpp v12, v16, v16 quad_perm:[1,0,3,2] row_mask:0xf bank_mask:0xf
    s_nop 1
    v_add_f32_dpp v16, v12, v12 quad_perm:[2,3,0,1] row_mask:0xf bank_mask:0xf
    v_cvt_pk_bf16_f32 v16, v16, v16
    v_and_b32 v16, 0xffff0000, v16
    v_mul_f32 v16, 0x3db504f3, v16
    v_cvt_pk_bf16_f32 v16, v16, v16
    v_and_b32 v16, 0xffff0000, v16
    v_cmp_gt_f32 vcc, v16, v10
    s_cbranch_vccnz L_resc_1
L_back_1:
    v_fma_f32 v12, v16, s20, -v18
    v_exp_f32 v12, v12
    s_nop 0
    v_cvt_pk_bf16_f32 v19, v12, v12
    v_add_f32 v11, v11, v12
    s_nop 0
    v_and_b32_dpp v40, v19, v44 row_newbcast:0 row_mask:0xf bank_mask:0xf
    v_and_b32_dpp v41, v19, v45 row_newbcast:0 row_mask:0xf bank_mask:0xf
    v_and_b32_dpp v42, v19, v46 row_newbcast:0 row_mask:0xf bank_mask:0xf
    v_and_b32_dpp v43, v19, v47 row_newbcast:0 row_mask:0xf bank_mask:0xf
    s_waitcnt vmcnt(15)
    s_nop 0
    v_mfma_f32_16x16x32_bf16 v[20:23], v[40:43], v[112:115], v[20:23]
    buffer_load_dwordx4 v[112:115], v0, s[36:39], s94 offen offset:0 nt
    v_and_b32_dpp v40, v19, v44 row_newbcast:4 row_mask:0xf bank_mask:0xf
    v_and_b32_dpp v41, v19, v45 row_newbcast:4 row_mask:0xf bank_mask:0xf
    v_and_b32_dpp v42, v19, v46 row_newbcast:4 row_mask:0xf bank_mask:0xf
    v_and_b32_dpp v43, v19, v47 row_newbcast:4 row_mask:0xf bank_mask:0xf
    s_waitcnt vmcnt(15)
    s_nop 0
    v_mfma_f32_16x16x32_bf16 v[20:23], v[40:43], v[116:119], v[20:23]
    buffer_load_dwordx4 v[116:119], v0, s[36:39], s94 offen offset:256 nt
    v_and_b32_dpp v40, v19, v44 row_newbcast:8 row_mask:0xf bank_mask:0xf
    v_and_b32_dpp v41, v19, v45 row_newbcast:8 row_mask:0xf bank_mask:0xf
    v_and_b32_dpp v42, v19, v46 row_newbcast:8 row_mask:0xf bank_mask:0xf
    v_and_b32_dpp v43, v19, v47 row_newbcast:8 row_mask:0xf bank_mask:0xf
    s_waitcnt vmcnt(15)
    s_nop 0
    v_mfma_f32_16x16x32_bf16 v[20:23], v[40:43], v[120:123], v[20:23]
    buffer_load_dwordx4 v[120:123], v0, s[36:39], s94 offen offset:512 nt
    v_and_b32_dpp v40, v19, v44 row_newbcast:12 row_mask:0xf bank_mask:0xf
    v_and_b32_dpp v41, v19, v45 row_newbcast:12 row_mask:0xf bank_mask:0xf
    v_and_b32_dpp v42, v19, v46 row_newbcast:12 row_mask:0xf bank_mask:0xf
    v_and_b32_dpp v43, v19, v47 row_newbcast:12 row_mask:0xf bank_mask:0xf
    s_waitcnt vmcnt(15)
    s_nop 0
    v_mfma_f32_16x16x32_bf16 v[20:23], v[40:43], v[124:127], v[20:23]
    buffer_load_dwordx4 v[124:127], v0, s[36:39], s94 offen offset:768 nt
    s_cmp_eq_u32 s23, 0
    s_cbranch_scc1 L_loop
L_extras:
    s_mov_b32 s23, 0
    v_mfma_f32_16x16x32_bf16 v[36:39], v[128:131], v[48:51], 0
    v_mfma_f32_16x16x32_bf16 v[36:39], v[132:135], v[52:55], v[36:39]
    v_mfma_f32_16x16x32_bf16 v[36:39], v[136:139], v[56:59], v[36:39]
    v_mfma_f32_16x16x32_bf16 v[36:39], v[140:143], v[60:63], v[36:39]
    s_nop 7
    v_cndmask_b32 v16, v36, v37, s[80:81]
    v_cndmask_b32 v16, v16, v38, s[82:83]
    v_cndmask_b32 v16, v16, v39, s[84:85]
    s_nop 1
    v_add_f32_dpp v12, v16, v16 quad_perm:[1,0,3,2] row_mask:0xf bank_mask:0xf
    s_nop 1
    v_add_f32_dpp v16, v12, v12 quad_perm:[2,3,0,1] row_mask:0xf bank_mask:0xf
    v_cvt_pk_bf16_f32 v16, v16, v16
    v_and_b32 v16, 0xffff0000, v16
    v_mul_f32 v16, 0x3db504f3, v16
    v_cvt_pk_bf16_f32 v16, v16, v16
    v_and_b32 v16, 0xffff0000, v16
    v_cmp_gt_f32 vcc, v16, v10
    s_cbranch_vccnz L_resc_2
L_back_2:
    v_fma_f32 v12, v16, s20, -v18
    v_exp_f32 v12, v12
    s_nop 0
    v_cvt_pk_bf16_f32 v19, v12, v12
    v_add_f32 v11, v11, v12
    s_nop 0
    v_and_b32_dpp v40, v19, v44 row_newbcast:0 row_mask:0xf bank_mask:0xf
    v_and_b32_dpp v41, v19, v45 row_newbcast:0 row_mask:0xf bank_mask:0xf
    v_and_b32_dpp v42, v19, v46 row_newbcast:0 row_mask:0xf bank_mask:0xf
    v_and_b32_dpp v43, v19, v47 row_newbcast:0 row_mask:0xf bank_mask:0xf
    s_nop 1
    v_mfma_f32_16x16x32_bf16 v[20:23], v[40:43], v[144:147], v[20:23]
    v_and_b32_dpp v40, v19, v44 row_newbcast:4 row_mask:0xf bank_mask:0xf
    v_and_b32_dpp v41, v19, v45 row_newbcast:4 row_mask:0xf bank_mask:0xf
    v_and_b32_dpp v42, v19, v46 row_newbcast:4 row_mask:0xf bank_mask:0xf
    v_and_b32_dpp v43, v19, v47 row_newbcast:4 row_mask:0xf bank_mask:0xf
    s_nop 1
    v_mfma_f32_16x16x32_bf16 v[20:23], v[40:43], v[148:151], v[20:23]
    v_and_b32_dpp v40, v19, v44 row_newbcast:8 row_mask:0xf bank_mask:0xf
    v_and_b32_dpp v41, v19, v45 row_newbcast:8 row_mask:0xf bank_mask:0xf
    v_and_b32_dpp v42, v19, v46 row_newbcast:8 row_mask:0xf bank_mask:0xf
    v_and_b32_dpp v43, v19, v47 row_newbcast:8 row_mask:0xf bank_mask:0xf
    s_nop 1
    v_mfma_f32_16x16x32_bf16 v[20:23], v[40:43], v[152:155], v[20:23]
    v_and_b32_dpp v40, v19, v44 row_newbcast:12 row_mask:0xf bank_mask:0xf
    v_and_b32_dpp v41, v19, v45 row_newbcast:12 row_mask:0xf bank_mask:0xf
    v_and_b32_dpp v42, v19, v46 row_newbcast:12 row_mask:0xf bank_mask:0xf
    v_and_b32_dpp v43, v19, v47 row_newbcast:12 row_mask:0xf bank_mask:0xf
    s_nop 1
    v_mfma_f32_16x16x32_bf16 v[20:23], v[40:43], v[156:159], v[20:23]
    v_mfma_f32_16x16x32_bf16 v[36:39], v[160:163], v[48:51], 0
    v_mfma_f32_16x16x32_bf16 v[36:39], v[164:167], v[52:55], v[36:39]
    v_mfma_f32_16x16x32_bf16 v[36:39], v[168:171], v[56:59], v[36:39]
    v_mfma_f32_16x16x32_bf16 v[36:39], v[172:175], v[60:63], v[36:39]
    s_nop 7
    v_cndmask_b32 v16, v36, v37, s[80:81]
    v_cndmask_b32 v16, v16, v38, s[82:83]
    v_cndmask_b32 v16, v16, v39, s[84:85]
    s_nop 1
    v_add_f32_dpp v12, v16, v16 quad_perm:[1,0,3,2] row_mask:0xf bank_mask:0xf
    s_nop 1
    v_add_f32_dpp v16, v12, v12 quad_perm:[2,3,0,1] row_mask:0xf bank_mask:0xf
    v_cvt_pk_bf16_f32 v16, v16, v16
    v_and_b32 v16, 0xffff0000, v16
    v_mul_f32 v16, 0x3db504f3, v16
    v_cvt_pk_bf16_f32 v16, v16, v16
    v_and_b32 v16, 0xffff0000, v16
    v_cmp_gt_f32 vcc, v16, v10
    s_cbranch_vccnz L_resc_3
L_back_3:
    v_fma_f32 v12, v16, s20, -v18
    v_exp_f32 v12, v12
    s_nop 0
    v_cvt_pk_bf16_f32 v19, v12, v12
    v_add_f32 v11, v11, v12
    s_nop 0
    v_and_b32_dpp v40, v19, v44 row_newbcast:0 row_mask:0xf bank_mask:0xf
    v_and_b32_dpp v41, v19, v45 row_newbcast:0 row_mask:0xf bank_mask:0xf
    v_and_b32_dpp v42, v19, v46 row_newbcast:0 row_mask:0xf bank_mask:0xf
    v_and_b32_dpp v43, v19, v47 row_newbcast:0 row_mask:0xf bank_mask:0xf
    s_nop 1
    v_mfma_f32_16x16x32_bf16 v[20:23], v[40:43], v[176:179], v[20:23]
    v_and_b32_dpp v40, v19, v44 row_newbcast:4 row_mask:0xf bank_mask:0xf
    v_and_b32_dpp v41, v19, v45 row_newbcast:4 row_mask:0xf bank_mask:0xf
    v_and_b32_dpp v42, v19, v46 row_newbcast:4 row_mask:0xf bank_mask:0xf
    v_and_b32_dpp v43, v19, v47 row_newbcast:4 row_mask:0xf bank_mask:0xf
    s_nop 1
    v_mfma_f32_16x16x32_bf16 v[20:23], v[40:43], v[180:183], v[20:23]
    v_and_b32_dpp v40, v19, v44 row_newbcast:8 row_mask:0xf bank_mask:0xf
    v_and_b32_dpp v41, v19, v45 row_newbcast:8 row_mask:0xf bank_mask:0xf
    v_and_b32_dpp v42, v19, v46 row_newbcast:8 row_mask:0xf bank_mask:0xf
    v_and_b32_dpp v43, v19, v47 row_newbcast:8 row_mask:0xf bank_mask:0xf
    s_nop 1
    v_mfma_f32_16x16x32_bf16 v[20:23], v[40:43], v[184:187], v[20:23]
    v_and_b32_dpp v40, v19, v44 row_newbcast:12 row_mask:0xf bank_mask:0xf
    v_and_b32_dpp v41, v19, v45 row_newbcast:12 row_mask:0xf bank_mask:0xf
    v_and_b32_dpp v42, v19, v46 row_newbcast:12 row_mask:0xf bank_mask:0xf
    v_and_b32_dpp v43, v19, v47 row_newbcast:12 row_mask:0xf bank_mask:0xf
    s_nop 1
    v_mfma_f32_16x16x32_bf16 v[20:23], v[40:43], v[188:191], v[20:23]
    s_cmp_eq_u32 s22, 3
    s_cbranch_scc1 L_done
    s_branch L_loop
L_dyn0:
    s_waitcnt vmcnt(17)
L_dynb0:
    v_readfirstlane_b32 s97, v24
    v_readfirstlane_b32 s98, v25
    s_cmp_lg_u32 s98, s27
    s_cbranch_scc1 L_dfx0
    s_and_b32 s98, s97, 0xffff
    s_lshr_b32 s97, s97, 16
    s_cmp_eq_u32 s66, 0
    s_cselect_b32 s96, s98, s97
    s_add_u32 s97, s97, s98
    s_cmp_lt_u32 s97, 32
    s_cbranch_scc0 L_dx0
L_dgo0:
    v_mov_b32 v24, s67
    v_mov_b32 v25, 0
    s_mov_b64 exec, 1
    buffer_atomic_add_x2 v[24:25], v5, s[52:55], s101 offen sc0 sc1
    s_mov_b64 exec, -1
    s_add_u32 s96, s96, 112
    s_xor_b32 s5, s96, s66
    s_and_b32 s94, s5, 0x1
    s_lshl_b32 s94, s94, 13
    s_and_b32 s6, s5, 0x2
    s_lshl_b32 s6, s6, 10
    s_or_b32 s94, s94, s6
    s_and_b32 s6, s5, 0x4
    s_lshl_b32 s6, s6, 8
    s_or_b32 s94, s94, s6
    s_and_b32 s6, s5, 0x8
    s_lshl_b32 s6, s6, 13
    s_or_b32 s94, s94, s6
    s_and_b32 s6, s5, 0x10
    s_lshl_b32 s6, s6, 8
    s_or_b32 s94, s94, s6
    s_and_b32 s6, s5, 0xe0
    s_lshl_b32 s6, s6, 12
    s_or_b32 s94, s94, s6
    s_waitcnt vmcnt(17)
    v_mfma_f32_16x16x32_bf16 v[36:39], v[64:67], v[48:51], 0
    buffer_load_dwordx4 v[64:67], v4, s[32:35], s94 offen offset:0 nt
    s_waitcnt vmcnt(17)
    v_mfma_f32_16x16x32_bf16 v[36:39], v[68:71], v[52:55], v[36:39]
    buffer_load_dwordx4 v[68:71], v4, s[32:35], s94 offen offset:256 nt
    s_waitcnt vmcnt(17)
    v_mfma_f32_16x16x32_bf16 v[36:39], v[72:75], v[56:59], v[36:39]
    buffer_load_dwordx4 v[72:75], v4, s[32:35], s94 offen offset:512 nt
    s_waitcnt vmcnt(17)
    v_mfma_f32_16x16x32_bf16 v[36:39], v[76:79], v[60:63], v[36:39]
    buffer_load_dwordx4 v[76:79], v4, s[32:35], s94 offen offset:768 nt
    s_nop 6
    v_cndmask_b32 v16, v36, v37, s[80:81]
    v_cndmask_b32 v16, v16, v38, s[82:83]
    v_cndmask_b32 v16, v16, v39, s[84:85]
    s_nop 1
    v_add_f32_dpp v12, v16, v16 quad_perm:[1,0,3,2] row_mask:0xf bank_mask:0xf
    s_nop 1
    v_add_f32_dpp v16, v12, v12 quad_perm:[2,3,0,1] row_mask:0xf bank_mask:0xf
    v_cvt_pk_bf16_f32 v16, v16, v16
    v_and_b32 v16, 0xffff0000, v16
    v_mul_f32 v16, 0x3db504f3, v16
    v_cvt_pk_bf16_f32 v16, v16, v16
    v_and_b32 v16, 0xffff0000, v16
    v_cmp_gt_f32 vcc, v16, v10
    s_cbranch_vccnz L_resc_4
L_back_4:
    v_fma_f32 v12, v16, s20, -v18
    v_exp_f32 v12, v12
    s_nop 0
    v_cvt_pk_bf16_f32 v19, v12, v12
    v_add_f32 v11, v11, v12
    s_nop 0
    v_and_b32_dpp v40, v19, v44 row_newbcast:0 row_mask:0xf bank_mask:0xf
    v_and_b32_dpp v41, v19, v45 row_newbcast:0 row_mask:0xf bank_mask:0xf
    v_and_b32_dpp v42, v19, v46 row_newbcast:0 row_mask:0xf bank_mask:0xf
    v_and_b32_dpp v43, v19, v47 row_newbcast:0 row_mask:0xf bank_mask:0xf
    s_waitcnt vmcnt(17)
    s_nop 0
    v_mfma_f32_16x16x32_bf16 v[20:23], v[40:43], v[80:83], v[20:23]
    buffer_load_dwordx4 v[80:83], v0, s[36:39], s94 offen offset:0 nt
    v_and_b32_dpp v40, v19, v44 row_newbcast:4 row_mask:0xf bank_mask:0xf
    v_and_b32_dpp v41, v19, v45 row_newbcast:4 row_mask:0xf bank_mask:0xf
    v_and_b32_dpp v42, v19, v46 row_newbcast:4 row_mask:0xf bank_mask:0xf
    v_and_b32_dpp v43, v19, v47 row_newbcast:4 row_mask:0xf bank_mask:0xf
    s_waitcnt vmcnt(17)
    s_nop 0
    v_mfma_f32_16x16x32_bf16 v[20:23], v[40:43], v[84:87], v[20:23]
    buffer_load_dwordx4 v[84:87], v0, s[36:39], s94 offen offset:256 nt
    v_and_b32_dpp v40, v19, v44 row_newbcast:8 row_mask:0xf bank_mask:0xf
    v_and_b32_dpp v41, v19, v45 row_newbcast:8 row_mask:0xf bank_mask:0xf
    v_and_b32_dpp v42, v19, v46 row_newbcast:8 row_mask:0xf bank_mask:0xf
    v_and_b32_dpp v43, v19, v47 row_newbcast:8 row_mask:0xf bank_mask:0xf
    s_waitcnt vmcnt(17)
    s_nop 0
    v_mfma_f32_16x16x32_bf16 v[20:23], v[40:43], v[88:91], v[20:23]
    buffer_load_dwordx4 v[88:91], v0, s[36:39], s94 offen offset:512 nt
    v_and_b32_dpp v40, v19, v44 row_newbcast:12 row_mask:0xf bank_mask:0xf
    v_and_b32_dpp v41, v19, v45 row_newbcast:12 row_mask:0xf bank_mask:0xf
    v_and_b32_dpp v42, v19, v46 row_newbcast:12 row_mask:0xf bank_mask:0xf
    v_and_b32_dpp v43, v19, v47 row_newbcast:12 row_mask:0xf bank_mask:0xf
    s_waitcnt vmcnt(17)
    s_nop 0
    v_mfma_f32_16x16x32_bf16 v[20:23], v[40:43], v[92:95], v[20:23]
    buffer_load_dwordx4 v[92:95], v0, s[36:39], s94 offen offset:768 nt
L_dyn1:
    s_waitcnt vmcnt(17)
L_dynb1:
    v_readfirstlane_b32 s97, v26
    v_readfirstlane_b32 s98, v27
    s_cmp_lg_u32 s98, s27
    s_cbranch_scc1 L_dfx1
    s_and_b32 s98, s97, 0xffff
    s_lshr_b32 s97, s97, 16
    s_cmp_eq_u32 s66, 0
    s_cselect_b32 s96, s98, s97
    s_add_u32 s97, s97, s98
    s_cmp_lt_u32 s97, 32
    s_cbranch_scc0 L_dx1
L_dgo1:
    v_mov_b32 v26, s67
    v_mov_b32 v27, 0
    s_mov_b64 exec, 1
    buffer_atomic_add_x2 v[26:27], v5, s[52:55], s101 offen sc0 sc1
    s_mov_b64 exec, -1
    s_add_u32 s96, s96, 112
    s_xor_b32 s5, s96, s66
    s_and_b32 s94, s5, 0x1
    s_lshl_b32 s94, s94, 13
    s_and_b32 s6, s5, 0x2
    s_lshl_b32 s6, s6, 10
    s_or_b32 s94, s94, s6
    s_and_b32 s6, s5, 0x4
    s_lshl_b32 s6, s6, 8
    s_or_b32 s94, s94, s6
    s_and_b32 s6, s5, 0x8
    s_lshl_b32 s6, s6, 13
    s_or_b32 s94, s94, s6
    s_and_b32 s6, s5, 0x10
    s_lshl_b32 s6, s6, 8
    s_or_b32 s94, s94, s6
    s_and_b32 s6, s5, 0xe0
    s_lshl_b32 s6, s6, 12
    s_or_b32 s94, s94, s6
    s_waitcnt vmcnt(17)
    v_mfma_f32_16x16x32_bf16 v[36:39], v[96:99], v[48:51], 0
    buffer_load_dwordx4 v[96:99], v4, s[32:35], s94 offen offset:0 nt
    s_waitcnt vmcnt(17)
    v_mfma_f32_16x16x32_bf16 v[36:39], v[100:103], v[52:55], v[36:39]
    buffer_load_dwordx4 v[100:103], v4, s[32:35], s94 offen offset:256 nt
    s_waitcnt vmcnt(17)
    v_mfma_f32_16x16x32_bf16 v[36:39], v[104:107], v[56:59], v[36:39]
    buffer_load_dwordx4 v[104:107], v4, s[32:35], s94 offen offset:512 nt
    s_waitcnt vmcnt(17)
    v_mfma_f32_16x16x32_bf16 v[36:39], v[108:111], v[60:63], v[36:39]
    buffer_load_dwordx4 v[108:111], v4, s[32:35], s94 offen offset:768 nt
    s_nop 6
    v_cndmask_b32 v16, v36, v37, s[80:81]
    v_cndmask_b32 v16, v16, v38, s[82:83]
    v_cndmask_b32 v16, v16, v39, s[84:85]
    s_nop 1
    v_add_f32_dpp v12, v16, v16 quad_perm:[1,0,3,2] row_mask:0xf bank_mask:0xf
    s_nop 1
    v_add_f32_dpp v16, v12, v12 quad_perm:[2,3,0,1] row_mask:0xf bank_mask:0xf
    v_cvt_pk_bf16_f32 v16, v16, v16
    v_and_b32 v16, 0xffff0000, v16
    v_mul_f32 v16, 0x3db504f3, v16
    v_cvt_pk_bf16_f32 v16, v16, v16
    v_and_b32 v16, 0xffff0000, v16
    v_cmp_gt_f32 vcc, v16, v10
    s_cbranch_vccnz L_resc_5
L_back_5:
    v_fma_f32 v12, v16, s20, -v18
    v_exp_f32 v12, v12
    s_nop 0
    v_cvt_pk_bf16_f32 v19, v12, v12
    v_add_f32 v11, v11, v12
    s_nop 0
    v_and_b32_dpp v40, v19, v44 row_newbcast:0 row_mask:0xf bank_mask:0xf
    v_and_b32_dpp v41, v19, v45 row_newbcast:0 row_mask:0xf bank_mask:0xf
    v_and_b32_dpp v42, v19, v46 row_newbcast:0 row_mask:0xf bank_mask:0xf
    v_and_b32_dpp v43, v19, v47 row_newbcast:0 row_mask:0xf bank_mask:0xf
    s_waitcnt vmcnt(17)
    s_nop 0
    v_mfma_f32_16x16x32_bf16 v[20:23], v[40:43], v[112:115], v[20:23]
    buffer_load_dwordx4 v[112:115], v0, s[36:39], s94 offen offset:0 nt
    v_and_b32_dpp v40, v19, v44 row_newbcast:4 row_mask:0xf bank_mask:0xf
    v_and_b32_dpp v41, v19, v45 row_newbcast:4 row_mask:0xf bank_mask:0xf
    v_and_b32_dpp v42, v19, v46 row_newbcast:4 row_mask:0xf bank_mask:0xf
    v_and_b32_dpp v43, v19, v47 row_newbcast:4 row_mask:0xf bank_mask:0xf
    s_waitcnt vmcnt(17)
    s_nop 0
    v_mfma_f32_16x16x32_bf16 v[20:23], v[40:43], v[116:119], v[20:23]
    buffer_load_dwordx4 v[116:119], v0, s[36:39], s94 offen offset:256 nt
    v_and_b32_dpp v40, v19, v44 row_newbcast:8 row_mask:0xf bank_mask:0xf
    v_and_b32_dpp v41, v19, v45 row_newbcast:8 row_mask:0xf bank_mask:0xf
    v_and_b32_dpp v42, v19, v46 row_newbcast:8 row_mask:0xf bank_mask:0xf
    v_and_b32_dpp v43, v19, v47 row_newbcast:8 row_mask:0xf bank_mask:0xf
    s_waitcnt vmcnt(17)
    s_nop 0
    v_mfma_f32_16x16x32_bf16 v[20:23], v[40:43], v[120:123], v[20:23]
    buffer_load_dwordx4 v[120:123], v0, s[36:39], s94 offen offset:512 nt
    v_and_b32_dpp v40, v19, v44 row_newbcast:12 row_mask:0xf bank_mask:0xf
    v_and_b32_dpp v41, v19, v45 row_newbcast:12 row_mask:0xf bank_mask:0xf
    v_and_b32_dpp v42, v19, v46 row_newbcast:12 row_mask:0xf bank_mask:0xf
    v_and_b32_dpp v43, v19, v47 row_newbcast:12 row_mask:0xf bank_mask:0xf
    s_waitcnt vmcnt(17)
    s_nop 0
    v_mfma_f32_16x16x32_bf16 v[20:23], v[40:43], v[124:127], v[20:23]
    buffer_load_dwordx4 v[124:127], v0, s[36:39], s94 offen offset:768 nt
    s_branch L_dyn0
L_pre0:
    s_cmp_eq_u32 s22, 2
    s_cbranch_scc1 L_pslow0
    s_cmp_eq_u32 s22, 1
    s_cbranch_scc1 L_dent0
    v_mov_b32 v24, s67
    v_mov_b32 v25, 0
    s_mov_b64 exec, 1
    buffer_atomic_add_x2 v[24:25], v5, s[52:55], s101 offen sc0 sc1
    s_mov_b64 exec, -1
    v_mov_b32 v26, s67
    v_mov_b32 v27, 0
    s_mov_b64 exec, 1
    buffer_atomic_add_x2 v[26:27], v5, s[52:55], s101 offen sc0 sc1
    s_mov_b64 exec, -1
    s_mov_b32 s22, 1
    s_mov_b32 s95, 112
    s_mov_b32 s19, 0
    s_cmp_lt_u32 s96, 112
    s_cbranch_scc0 L_dent00
    s_mov_b64 exec, 1
    ds_add_rtn_u32 v7, v5, v17 offset:8256
    s_mov_b64 exec, -1
    s_branch L_preb0
L_dent00:
    s_waitcnt vmcnt(0)
L_dent0:
    s_waitcnt vmcnt(8)
    s_branch L_dynb0
L_pslow0:
    s_cmp_ge_u32 s96, 112
    s_cbranch_scc1 L_tail0
    v_mov_b32 v7, 112
    s_setprio 2
    s_branch L_preb0
L_dx0:
    s_waitcnt vmcnt(8)
    v_readfirstlane_b32 s97, v26
    v_readfirstlane_b32 s98, v27
    s_cmp_lg_u32 s98, s27
    s_cbranch_scc1 L_dfo0
    s_and_b32 s98, s97, 0xffff
    s_lshr_b32 s97, s97, 16
    s_cmp_eq_u32 s66, 0
    s_cselect_b32 s96, s98, s97
    s_add_u32 s97, s97, s98
    s_cmp_lt_u32 s97, 32
    s_cbranch_scc0 L_dquit0
    v_mov_b32 v26, -1
    s_branch L_dgo0
L_dfx0:
    s_add_u32 s19, s19, 1
    s_cmp_ge_u32 s19, 0x400000
    s_cbranch_scc1 L_dquitw0
    s_sleep 8
    v_mov_b32 v24, s67
    v_mov_b32 v25, 0
    s_mov_b64 exec, 1
    buffer_atomic_add_x2 v[24:25], v5, s[52:55], s101 offen sc0 sc1
    s_mov_b64 exec, -1
    s_waitcnt vmcnt(0)
    s_branch L_dynb0
L_dfo0:
    s_add_u32 s19, s19, 1
    s_cmp_ge_u32 s19, 0x400000
    s_cbranch_scc1 L_dquitw0
    s_sleep 8
    v_mov_b32 v26, s67
    v_mov_b32 v27, 0
    s_mov_b64 exec, 1
    buffer_atomic_add_x2 v[26:27], v5, s[52:55], s101 offen sc0 sc1
    s_mov_b64 exec, -1
    s_waitcnt vmcnt(0)
    s_branch L_dx0
L_dquitw0:
    s_waitcnt vmcnt(0)
L_dquit0:
    s_mov_b64 exec, 1
    ds_write_b32 v5, v17 offset:8264
    s_mov_b64 exec, -1
    s_branch L_tail0
L_pre1:
    s_cmp_eq_u32 s22, 2
    s_cbranch_scc1 L_pslow1
    s_cmp_eq_u32 s22, 1
    s_cbranch_scc1 L_dent1
    v_mov_b32 v24, s67
    v_mov_b32 v25, 0
    s_mov_b64 exec, 1
    buffer_atomic_add_x2 v[24:25], v5, s[52:55], s101 offen sc0 sc1
    s_mov_b64 exec, -1
    v_mov_b32 v26, s67
    v_mov_b32 v27, 0
    s_mov_b64 exec, 1
    buffer_atomic_add_x2 v[26:27], v5, s[52:55], s101 offen sc0 sc1
    s_mov_b64 exec, -1
    s_mov_b32 s22, 1
    s_mov_b32 s95, 112
    s_mov_b32 s19, 0
    s_cmp_lt_u32 s96, 112
    s_cbranch_scc0 L_dent01
    s_mov_b64 exec, 1
    ds_add_rtn_u32 v7, v5, v17 offset:8256
    s_mov_b64 exec, -1
    s_branch L_preb1
L_dent01:
    s_waitcnt vmcnt(0)
L_dent1:
    s_waitcnt vmcnt(8)
    v_swap_b32 v24, v26
    v_swap_b32 v25, v27
    s_nop 0
    s_branch L_dynb1
L_pslow1:
    s_cmp_ge_u32 s96, 112
    s_cbranch_scc1 L_tail1
    v_mov_b32 v7, 112
    s_setprio 2
    s_branch L_preb1
L_dx1:
    s_waitcnt vmcnt(8)
    v_readfirstlane_b32 s97, v24
    v_readfirstlane_b32 s98, v25
    s_cmp_lg_u32 s98, s27
    s_cbranch_scc1 L_dfo1
    s_and_b32 s98, s97, 0xffff
    s_lshr_b32 s97, s97, 16
    s_cmp_eq_u32 s66, 0
    s_cselect_b32 s96, s98, s97
    s_add_u32 s97, s97, s98
    s_cmp_lt_u32 s97, 32
    s_cbranch_scc0 L_dquit1
    v_mov_b32 v24, -1
    s_branch L_dgo1
L_dfx1:
    s_add_u32 s19, s19, 1
    s_cmp_ge_u32 s19, 0x400000
    s_cbranch_scc1 L_dquitw1
    s_sleep 8
    v_mov_b32 v26, s67
    v_mov_b32 v27, 0
    s_mov_b64 exec, 1
    buffer_atomic_add_x2 v[26:27], v5, s[52:55], s101 offen sc0 sc1
    s_mov_b64 exec, -1
    s_waitcnt vmcnt(0)
    s_branch L_dynb1
L_dfo1:
    s_add_u32 s19, s19, 1
    s_cmp_ge_u32 s19, 0x400000
    s_cbranch_scc1 L_dquitw1
    s_sleep 8
    v_mov_b32 v24, s67
    v_mov_b32 v25, 0
    s_mov_b64 exec, 1
    buffer_atomic_add_x2 v[24:25], v5, s[52:55], s101 offen sc0 sc1
    s_mov_b64 exec, -1
    s_waitcnt vmcnt(0)
    s_branch L_dx1
L_dquitw1:
    s_waitcnt vmcnt(0)
L_dquit1:
    s_mov_b64 exec, 1
    ds_write_b32 v5, v17 offset:8264
    s_mov_b64 exec, -1
    s_branch L_tail1
L_resc_0:
    s_nop 0
    v_max_f32_dpp v12, v16, v16 row_ror:4 row_mask:0xf bank_mask:0xf
    s_nop 1
    v_max_f32_dpp v13, v12, v12 row_ror:8 row_mask:0xf bank_mask:0xf
    s_nop 0
    v_readlane_b32 s97, v13, 0
    v_readlane_b32 s98, v13, 16
    v_readlane_b32 s99, v13, 32
    v_readlane_b32 s100, v13, 48
    s_nop 0
    v_max_f32 v13, s97, v10
    v_max_f32 v13, s98, v13
    v_max_f32 v13, s99, v13
    v_max_f32 v13, s100, v13
    v_sub_f32 v12, v10, v13
    v_mul_f32 v12, s20, v12
    v_exp_f32 v12, v12
    v_mov_b32 v10, v13
    v_mul_f32 v18, s20, v13
    v_mul_f32 v20, v20, v12
    v_mul_f32 v22, v22, v12
    v_mul_f32 v11, v11, v12
    s_branch L_back_0
L_resc_1:
    s_nop 0
    v_max_f32_dpp v12, v16, v16 row_ror:4 row_mask:0xf bank_mask:0xf
    s_nop 1
    v_max_f32_dpp v13, v12, v12 row_ror:8 row_mask:0xf bank_mask:0xf
    s_nop 0
    v_readlane_b32 s97, v13, 0
    v_readlane_b32 s98, v13, 16
    v_readlane_b32 s99, v13, 32
    v_readlane_b32 s100, v13, 48
    s_nop 0
    v_max_f32 v13, s97, v10
    v_max_f32 v13, s98, v13
    v_max_f32 v13, s99, v13
    v_max_f32 v13, s100, v13
    v_sub_f32 v12, v10, v13
    v_mul_f32 v12, s20, v12
    v_exp_f32 v12, v12
    v_mov_b32 v10, v13
    v_mul_f32 v18, s20, v13
    v_mul_f32 v20, v20, v12
    v_mul_f32 v22, v22, v12
    v_mul_f32 v11, v11, v12
    s_branch L_back_1
L_resc_2:
    s_nop 0
    v_max_f32_dpp v12, v16, v16 row_ror:4 row_mask:0xf bank_mask:0xf
    s_nop 1
    v_max_f32_dpp v13, v12, v12 row_ror:8 row_mask:0xf bank_mask:0xf
    s_nop 0
    v_readlane_b32 s97, v13, 0
    v_readlane_b32 s98, v13, 16
    v_readlane_b32 s99, v13, 32
    v_readlane_b32 s100, v13, 48
    s_nop 0
    v_max_f32 v13, s97, v10
    v_max_f32 v13, s98, v13
    v_max_f32 v13, s99, v13
    v_max_f32 v13, s100, v13
    v_sub_f32 v12, v10, v13
    v_mul_f32 v12, s20, v12
    v_exp_f32 v12, v12
    v_mov_b32 v10, v13
    v_mul_f32 v18, s20, v13
    v_mul_f32 v20, v20, v12
    v_mul_f32 v22, v22, v12
    v_mul_f32 v11, v11, v12
    s_branch L_back_2
L_resc_3:
    s_nop 0
    v_max_f32_dpp v12, v16, v16 row_ror:4 row_mask:0xf bank_mask:0xf
    s_nop 1
    v_max_f32_dpp v13, v12, v12 row_ror:8 row_mask:0xf bank_mask:0xf
    s_nop 0
    v_readlane_b32 s97, v13, 0
    v_readlane_b32 s98, v13, 16
    v_readlane_b32 s99, v13, 32
    v_readlane_b32 s100, v13, 48
    s_nop 0
    v_max_f32 v13, s97, v10
    v_max_f32 v13, s98, v13
    v_max_f32 v13, s99, v13
    v_max_f32 v13, s100, v13
    v_sub_f32 v12, v10, v13
    v_mul_f32 v12, s20, v12
    v_exp_f32 v12, v12
    v_mov_b32 v10, v13
    v_mul_f32 v18, s20, v13
    v_mul_f32 v20, v20, v12
    v_mul_f32 v22, v22, v12
    v_mul_f32 v11, v11, v12
    s_branch L_back_3
L_resc_4:
    s_nop 0
    v_max_f32_dpp v12, v16, v16 row_ror:4 row_mask:0xf bank_mask:0xf
    s_nop 1
    v_max_f32_dpp v13, v12, v12 row_ror:8 row_mask:0xf bank_mask:0xf
    s_nop 0
    v_readlane_b32 s97, v13, 0
    v_readlane_b32 s98, v13, 16
    v_readlane_b32 s99, v13, 32
    v_readlane_b32 s100, v13, 48
    s_nop 0
    v_max_f32 v13, s97, v10
    v_max_f32 v13, s98, v13
    v_max_f32 v13, s99, v13
    v_max_f32 v13, s100, v13
    v_sub_f32 v12, v10, v13
    v_mul_f32 v12, s20, v12
    v_exp_f32 v12, v12
    v_mov_b32 v10, v13
    v_mul_f32 v18, s20, v13
    v_mul_f32 v20, v20, v12
    v_mul_f32 v22, v22, v12
    v_mul_f32 v11, v11, v12
    s_branch L_back_4
L_resc_5:
    s_nop 0
    v_max_f32_dpp v12, v16, v16 row_ror:4 row_mask:0xf bank_mask:0xf
    s_nop 1
    v_max_f32_dpp v13, v12, v12 row_ror:8 row_mask:0xf bank_mask:0xf
    s_nop 0
    v_readlane_b32 s97, v13, 0
    v_readlane_b32 s98, v13, 16
    v_readlane_b32 s99, v13, 32
    v_readlane_b32 s100, v13, 48
    s_nop 0
    v_max_f32 v13, s97, v10
    v_max_f32 v13, s98, v13
    v_max_f32 v13, s99, v13
    v_max_f32 v13, s100, v13
    v_sub_f32 v12, v10, v13
    v_mul_f32 v12, s20, v12
    v_exp_f32 v12, v12
    v_mov_b32 v10, v13
    v_mul_f32 v18, s20, v13
    v_mul_f32 v20, v20, v12
    v_mul_f32 v22, v22, v12
    v_mul_f32 v11, v11, v12
    s_branch L_back_5
L_tail1:
    s_waitcnt vmcnt(8)
    v_mfma_f32_16x16x32_bf16 v[36:39], v[96:99], v[48:51], 0
    v_mfma_f32_16x16x32_bf16 v[36:39], v[100:103], v[52:55], v[36:39]
    v_mfma_f32_16x16x32_bf16 v[36:39], v[104:107], v[56:59], v[36:39]
    v_mfma_f32_16x16x32_bf16 v[36:39], v[108:111], v[60:63], v[36:39]
    s_nop 7
    v_cndmask_b32 v16, v36, v37, s[80:81]
    v_cndmask_b32 v16, v16, v38, s[82:83]
    v_cndmask_b32 v16, v16, v39, s[84:85]
    s_nop 1
    v_add_f32_dpp v12, v16, v16 quad_perm:[1,0,3,2] row_mask:0xf bank_mask:0xf
    s_nop 1
    v_add_f32_dpp v16, v12, v12 quad_perm:[2,3,0,1] row_mask:0xf bank_mask:0xf
    v_cvt_pk_bf16_f32 v16, v16, v16
    v_and_b32 v16, 0xffff0000, v16
    v_mul_f32 v16, 0x3db504f3, v16
    v_cvt_pk_bf16_f32 v16, v16, v16
    v_and_b32 v16, 0xffff0000, v16
    v_cmp_gt_f32 vcc, v16, v10
    s_cbranch_vccnz L_resc_6
L_back_6:
    v_fma_f32 v12, v16, s20, -v18
    v_exp_f32 v12, v12
    s_nop 0
    v_cvt_pk_bf16_f32 v19, v12, v12
    v_add_f32 v11, v11, v12
    s_nop 0
    v_and_b32_dpp v40, v19, v44 row_newbcast:0 row_mask:0xf bank_mask:0xf
    v_and_b32_dpp v41, v19, v45 row_newbcast:0 row_mask:0xf bank_mask:0xf
    v_and_b32_dpp v42, v19, v46 row_newbcast:0 row_mask:0xf bank_mask:0xf
    v_and_b32_dpp v43, v19, v47 row_newbcast:0 row_mask:0xf bank_mask:0xf
    s_nop 1
    v_mfma_f32_16x16x32_bf16 v[20:23], v[40:43], v[112:115], v[20:23]
    v_and_b32_dpp v40, v19, v44 row_newbcast:4 row_mask:0xf bank_mask:0xf
    v_and_b32_dpp v41, v19, v45 row_newbcast:4 row_mask:0xf bank_mask:0xf
    v_and_b32_dpp v42, v19, v46 row_newbcast:4 row_mask:0xf bank_mask:0xf
    v_and_b32_dpp v43, v19, v47 row_newbcast:4 row_mask:0xf bank_mask:0xf
    s_nop 1
    v_mfma_f32_16x16x32_bf16 v[20:23], v[40:43], v[116:119], v[20:23]
    v_and_b32_dpp v40, v19, v44 row_newbcast:8 row_mask:0xf bank_mask:0xf
    v_and_b32_dpp v41, v19, v45 row_newbcast:8 row_mask:0xf bank_mask:0xf
    v_and_b32_dpp v42, v19, v46 row_newbcast:8 row_mask:0xf bank_mask:0xf
    v_and_b32_dpp v43, v19, v47 row_newbcast:8 row_mask:0xf bank_mask:0xf
    s_nop 1
    v_mfma_f32_16x16x32_bf16 v[20:23], v[40:43], v[120:123], v[20:23]
    v_and_b32_dpp v40, v19, v44 row_newbcast:12 row_mask:0xf bank_mask:0xf
    v_and_b32_dpp v41, v19, v45 row_newbcast:12 row_mask:0xf bank_mask:0xf
    v_and_b32_dpp v42, v19, v46 row_newbcast:12 row_mask:0xf bank_mask:0xf
    v_and_b32_dpp v43, v19, v47 row_newbcast:12 row_mask:0xf bank_mask:0xf
    s_nop 1
    v_mfma_f32_16x16x32_bf16 v[20:23], v[40:43], v[124:127], v[20:23]
    s_waitcnt vmcnt(0)
    v_mfma_f32_16x16x32_bf16 v[36:39], v[64:67], v[48:51], 0
    v_mfma_f32_16x16x32_bf16 v[36:39], v[68:71], v[52:55], v[36:39]
    v_mfma_f32_16x16x32_bf16 v[36:39], v[72:75], v[56:59], v[36:39]
    v_mfma_f32_16x16x32_bf16 v[36:39], v[76:79], v[60:63], v[36:39]
    s_nop 7
    v_cndmask_b32 v16, v36, v37, s[80:81]
    v_cndmask_b32 v16, v16, v38, s[82:83]
    v_cndmask_b32 v16, v16, v39, s[84:85]
    s_nop 1
    v_add_f32_dpp v12, v16, v16 quad_perm:[1,0,3,2] row_mask:0xf bank_mask:0xf
    s_nop 1
    v_add_f32_dpp v16, v12, v12 quad_perm:[2,3,0,1] row_mask:0xf bank_mask:0xf
    v_cvt_pk_bf16_f32 v16, v16, v16
    v_and_b32 v16, 0xffff0000, v16
    v_mul_f32 v16, 0x3db504f3, v16
    v_cvt_pk_bf16_f32 v16, v16, v16
    v_and_b32 v16, 0xffff0000, v16
    v_cmp_gt_f32 vcc, v16, v10
    s_cbranch_vccnz L_resc_7
L_back_7:
    v_fma_f32 v12, v16, s20, -v18
    v_exp_f32 v12, v12
    s_nop 0
    v_cvt_pk_bf16_f32 v19, v12, v12
    v_add_f32 v11, v11, v12
    s_nop 0
    v_and_b32_dpp v40, v19, v44 row_newbcast:0 row_mask:0xf bank_mask:0xf
    v_and_b32_dpp v41, v19, v45 row_newbcast:0 row_mask:0xf bank_mask:0xf
    v_and_b32_dpp v42, v19, v46 row_newbcast:0 row_mask:0xf bank_mask:0xf
    v_and_b32_dpp v43, v19, v47 row_newbcast:0 row_mask:0xf bank_mask:0xf
    s_nop 1
    v_mfma_f32_16x16x32_bf16 v[20:23], v[40:43], v[80:83], v[20:23]
    v_and_b32_dpp v40, v19, v44 row_newbcast:4 row_mask:0xf bank_mask:0xf
    v_and_b32_dpp v41, v19, v45 row_newbcast:4 row_mask:0xf bank_mask:0xf
    v_and_b32_dpp v42, v19, v46 row_newbcast:4 row_mask:0xf bank_mask:0xf
    v_and_b32_dpp v43, v19, v47 row_newbcast:4 row_mask:0xf bank_mask:0xf
    s_nop 1
    v_mfma_f32_16x16x32_bf16 v[20:23], v[40:43], v[84:87], v[20:23]
    v_and_b32_dpp v40, v19, v44 row_newbcast:8 row_mask:0xf bank_mask:0xf
    v_and_b32_dpp v41, v19, v45 row_newbcast:8 row_mask:0xf bank_mask:0xf
    v_and_b32_dpp v42, v19, v46 row_newbcast:8 row_mask:0xf bank_mask:0xf
    v_and_b32_dpp v43, v19, v47 row_newbcast:8 row_mask:0xf bank_mask:0xf
    s_nop 1
    v_mfma_f32_16x16x32_bf16 v[20:23], v[40:43], v[88:91], v[20:23]
    v_and_b32_dpp v40, v19, v44 row_newbcast:12 row_mask:0xf bank_mask:0xf
    v_and_b32_dpp v41, v19, v45 row_newbcast:12 row_mask:0xf bank_mask:0xf
    v_and_b32_dpp v42, v19, v46 row_newbcast:12 row_mask:0xf bank_mask:0xf
    v_and_b32_dpp v43, v19, v47 row_newbcast:12 row_mask:0xf bank_mask:0xf
    s_nop 1
    v_mfma_f32_16x16x32_bf16 v[20:23], v[40:43], v[92:95], v[20:23]
    s_branch L_done
L_tail0:
    s_waitcnt vmcnt(8)
    v_mfma_f32_16x16x32_bf16 v[36:39], v[64:67], v[48:51], 0
    v_mfma_f32_16x16x32_bf16 v[36:39], v[68:71], v[52:55], v[36:39]
    v_mfma_f32_16x16x32_bf16 v[36:39], v[72:75], v[56:59], v[36:39]
    v_mfma_f32_16x16x32_bf16 v[36:39], v[76:79], v[60:63], v[36:39]
    s_nop 7
    v_cndmask_b32 v16, v36, v37, s[80:81]
    v_cndmask_b32 v16, v16, v38, s[82:83]
    v_cndmask_b32 v16, v16, v39, s[84:85]
    s_nop 1
    v_add_f32_dpp v12, v16, v16 quad_perm:[1,0,3,2] row_mask:0xf bank_mask:0xf
    s_nop 1
    v_add_f32_dpp v16, v12, v12 quad_perm:[2,3,0,1] row_mask:0xf bank_mask:0xf
    v_cvt_pk_bf16_f32 v16, v16, v16
    v_and_b32 v16, 0xffff0000, v16
    v_mul_f32 v16, 0x3db504f3, v16
    v_cvt_pk_bf16_f32 v16, v16, v16
    v_and_b32 v16, 0xffff0000, v16
    v_cmp_gt_f32 vcc, v16, v10
    s_cbranch_vccnz L_resc_8
L_back_8:
    v_fma_f32 v12, v16, s20, -v18
    v_exp_f32 v12, v12
    s_nop 0
    v_cvt_pk_bf16_f32 v19, v12, v12
    v_add_f32 v11, v11, v12
    s_nop 0
    v_and_b32_dpp v40, v19, v44 row_newbcast:0 row_mask:0xf bank_mask:0xf
    v_and_b32_dpp v41, v19, v45 row_newbcast:0 row_mask:0xf bank_mask:0xf
    v_and_b32_dpp v42, v19, v46 row_newbcast:0 row_mask:0xf bank_mask:0xf
    v_and_b32_dpp v43, v19, v47 row_newbcast:0 row_mask:0xf bank_mask:0xf
    s_nop 1
    v_mfma_f32_16x16x32_bf16 v[20:23], v[40:43], v[80:83], v[20:23]
    v_and_b32_dpp v40, v19, v44 row_newbcast:4 row_mask:0xf bank_mask:0xf
    v_and_b32_dpp v41, v19, v45 row_newbcast:4 row_mask:0xf bank_mask:0xf
    v_and_b32_dpp v42, v19, v46 row_newbcast:4 row_mask:0xf bank_mask:0xf
    v_and_b32_dpp v43, v19, v47 row_newbcast:4 row_mask:0xf bank_mask:0xf
    s_nop 1
    v_mfma_f32_16x16x32_bf16 v[20:23], v[40:43], v[84:87], v[20:23]
    v_and_b32_dpp v40, v19, v44 row_newbcast:8 row_mask:0xf bank_mask:0xf
    v_and_b32_dpp v41, v19, v45 row_newbcast:8 row_mask:0xf bank_mask:0xf
    v_and_b32_dpp v42, v19, v46 row_newbcast:8 row_mask:0xf bank_mask:0xf
    v_and_b32_dpp v43, v19, v47 row_newbcast:8 row_mask:0xf bank_mask:0xf
    s_nop 1
    v_mfma_f32_16x16x32_bf16 v[20:23], v[40:43], v[88:91], v[20:23]
    v_and_b32_dpp v40, v19, v44 row_newbcast:12 row_mask:0xf bank_mask:0xf
    v_and_b32_dpp v41, v19, v45 row_newbcast:12 row_mask:0xf bank_mask:0xf
    v_and_b32_dpp v42, v19, v46 row_newbcast:12 row_mask:0xf bank_mask:0xf
    v_and_b32_dpp v43, v19, v47 row_newbcast:12 row_mask:0xf bank_mask:0xf
    s_nop 1
    v_mfma_f32_16x16x32_bf16 v[20:23], v[40:43], v[92:95], v[20:23]
    s_waitcnt vmcnt(0)
    v_mfma_f32_16x16x32_bf16 v[36:39], v[96:99], v[48:51], 0
    v_mfma_f32_16x16x32_bf16 v[36:39], v[100:103], v[52:55], v[36:39]
    v_mfma_f32_16x16x32_bf16 v[36:39], v[104:107], v[56:59], v[36:39]
    v_mfma_f32_16x16x32_bf16 v[36:39], v[108:111], v[60:63], v[36:39]
    s_nop 7
    v_cndmask_b32 v16, v36, v37, s[80:81]
    v_cndmask_b32 v16, v16, v38, s[82:83]
    v_cndmask_b32 v16, v16, v39, s[84:85]
    s_nop 1
    v_add_f32_dpp v12, v16, v16 quad_perm:[1,0,3,2] row_mask:0xf bank_mask:0xf
    s_nop 1
    v_add_f32_dpp v16, v12, v12 quad_perm:[2,3,0,1] row_mask:0xf bank_mask:0xf
    v_cvt_pk_bf16_f32 v16, v16, v16
    v_and_b32 v16, 0xffff0000, v16
    v_mul_f32 v16, 0x3db504f3, v16
    v_cvt_pk_bf16_f32 v16, v16, v16
    v_and_b32 v16, 0xffff0000, v16
    v_cmp_gt_f32 vcc, v16, v10
    s_cbranch_vccnz L_resc_9
L_back_9:
    v_fma_f32 v12, v16, s20, -v18
    v_exp_f32 v12, v12
    s_nop 0
    v_cvt_pk_bf16_f32 v19, v12, v12
    v_add_f32 v11, v11, v12
    s_nop 0
    v_and_b32_dpp v40, v19, v44 row_newbcast:0 row_mask:0xf bank_mask:0xf
    v_and_b32_dpp v41, v19, v45 row_newbcast:0 row_mask:0xf bank_mask:0xf
    v_and_b32_dpp v42, v19, v46 row_newbcast:0 row_mask:0xf bank_mask:0xf
    v_and_b32_dpp v43, v19, v47 row_newbcast:0 row_mask:0xf bank_mask:0xf
    s_nop 1
    v_mfma_f32_16x16x32_bf16 v[20:23], v[40:43], v[112:115], v[20:23]
    v_and_b32_dpp v40, v19, v44 row_newbcast:4 row_mask:0xf bank_mask:0xf
    v_and_b32_dpp v41, v19, v45 row_newbcast:4 row_mask:0xf bank_mask:0xf
    v_and_b32_dpp v42, v19, v46 row_newbcast:4 row_mask:0xf bank_mask:0xf
    v_and_b32_dpp v43, v19, v47 row_newbcast:4 row_mask:0xf bank_mask:0xf
    s_nop 1
    v_mfma_f32_16x16x32_bf16 v[20:23], v[40:43], v[116:119], v[20:23]
    v_and_b32_dpp v40, v19, v44 row_newbcast:8 row_mask:0xf bank_mask:0xf
    v_and_b32_dpp v41, v19, v45 row_newbcast:8 row_mask:0xf bank_mask:0xf
    v_and_b32_dpp v42, v19, v46 row_newbcast:8 row_mask:0xf bank_mask:0xf
    v_and_b32_dpp v43, v19, v47 row_newbcast:8 row_mask:0xf bank_mask:0xf
    s_nop 1
    v_mfma_f32_16x16x32_bf16 v[20:23], v[40:43], v[120:123], v[20:23]
    v_and_b32_dpp v40, v19, v44 row_newbcast:12 row_mask:0xf bank_mask:0xf
    v_and_b32_dpp v41, v19, v45 row_newbcast:12 row_mask:0xf bank_mask:0xf
    v_and_b32_dpp v42, v19, v46 row_newbcast:12 row_mask:0xf bank_mask:0xf
    v_and_b32_dpp v43, v19, v47 row_newbcast:12 row_mask:0xf bank_mask:0xf
    s_nop 1
    v_mfma_f32_16x16x32_bf16 v[20:23], v[40:43], v[124:127], v[20:23]
L_done:
    s_mov_b32 s22, 3
    s_cmp_lg_u32 s23, 0
    s_cbranch_scc1 L_extras
    s_nop 1
    v_add_f32_dpp v12, v11, v11 row_ror:4 row_mask:0xf bank_mask:0xf
    s_nop 1
    v_add_f32_dpp v11, v12, v12 row_ror:8 row_mask:0xf bank_mask:0xf
    s_nop 0
    v_readlane_b32 s97, v11, 0
    v_readlane_b32 s98, v11, 16
    v_readlane_b32 s99, v11, 32
    v_readlane_b32 s100, v11, 48
    s_nop 1
    v_mov_b32 v11, s97
    v_add_f32 v11, s98, v11
    v_add_f32 v11, s99, v11
    v_add_f32 v11, s100, v11
    ds_write2_b32 v9, v20, v22 offset0:0 offset1:1
    s_lshl_b32 s97, s16, 3
    v_mov_b32 v12, s97
    s_mov_b64 exec, 1
    ds_write_b64 v12, v[10:11] offset:8192
    ds_add_rtn_u32 v7, v5, v17 offset:8268
    s_mov_b64 exec, -1
    v_mov_b32 v13, 0
    ds_read_b128 v[192:195], v13 offset:8192
    ds_read_b128 v[196:199], v13 offset:8208
    ds_read_b128 v[200:203], v13 offset:8224
    ds_read_b128 v[204:207], v13 offset:8240
    v_lshlrev_b32 v12, 3, v1
    ds_read_b64 v[208:209], v12 offset:4096
    ds_read_b64 v[210:211], v12 offset:4608
    ds_read_b64 v[212:213], v12 offset:5632
    ds_read_b64 v[214:215], v12 offset:6144
    ds_read_b64 v[216:217], v12 offset:6656
    ds_read_b64 v[218:219], v12 offset:7168
    ds_read_b64 v[220:221], v12 offset:7680
    s_lshl_b32 s98, s25, 10
    s_add_u32 s98, s98, 266240
    s_mov_b32 s64, 0xaaaaaaaa
    s_mov_b32 s65, 0xaaaaaaaa
    v_mov_b32 v43, s27
    v_and_b32 v15, 3, v1
    v_lshlrev_b32 v15, 8, v15
    v_lshrrev_b32 v14, 2, v1
    v_lshl_add_u32 v15, v14, 4, v15
    s_waitcnt lgkmcnt(11)
    v_readfirstlane_b32 s97, v7
    s_cmp_lg_u32 s97, 6
    s_cbranch_scc1 L_finw
L_comb2:
    s_waitcnt lgkmcnt(7)
    v_max3_f32 v10, v192, v194, v198
    v_max3_f32 v10, v10, v200, v202
    v_max3_f32 v10, v10, v204, v206
    v_sub_f32 v192, v192, v10
    v_sub_f32 v194, v194, v10
    v_sub_f32 v198, v198, v10
    v_sub_f32 v200, v200, v10
    v_sub_f32 v202, v202, v10
    v_sub_f32 v204, v204, v10
    v_sub_f32 v206, v206, v10
    v_mul_f32 v192, s20, v192
    v_mul_f32 v194, s20, v194
    v_mul_f32 v198, s20, v198
    v_mul_f32 v200, s20, v200
    v_mul_f32 v202, s20, v202
    v_mul_f32 v204, s20, v204
    v_mul_f32 v206, s20, v206
    v_exp_f32 v192, v192
    v_exp_f32 v194, v194
    v_exp_f32 v198, v198
    v_exp_f32 v200, v200
    v_exp_f32 v202, v202
    v_exp_f32 v204, v204
    v_exp_f32 v206, v206
    v_mul_f32 v11, v192, v193
    v_fmac_f32 v11, v194, v195
    v_fmac_f32 v11, v198, v199
    v_fmac_f32 v11, v200, v201
    v_fmac_f32 v11, v202, v203
    v_fmac_f32 v11, v204, v205
    v_fmac_f32 v11, v206, v207
    s_waitcnt lgkmcnt(6)
    v_mul_f32 v40, v192, v208
    v_mul_f32 v41, v192, v209
    s_waitcnt lgkmcnt(5)
    v_fmac_f32 v40, v194, v210
    v_fmac_f32 v41, v194, v211
    s_waitcnt lgkmcnt(4)
    v_fmac_f32 v40, v198, v212
    v_fmac_f32 v41, v198, v213
    s_waitcnt lgkmcnt(3)
    v_fmac_f32 v40, v200, v214
    v_fmac_f32 v41, v200, v215
    s_waitcnt lgkmcnt(2)
    v_fmac_f32 v40, v202, v216
    v_fmac_f32 v41, v202, v217
    s_waitcnt lgkmcnt(1)
    v_fmac_f32 v40, v204, v218
    v_fmac_f32 v41, v204, v219
    s_waitcnt lgkmcnt(0)
    v_fmac_f32 v40, v206, v220
    v_fmac_f32 v41, v206, v221
    v_cndmask_b32 v42, v10, v11, s[64:65]
    buffer_store_dwordx4 v[40:43], v15, s[52:55], s98 offen sc1
    s_branch L_fin
L_ogather:
    s_cmp_lt_u32 s3, 168
    s_cbranch_scc1 L_og1
    s_waitcnt vmcnt(16)
    ds_read_b64_tr_b16 v[64:65], v48 offset:49152
    ds_read_b64_tr_b16 v[66:67], v48 offset:49664
    ds_read_b64_tr_b16 v[80:81], v49 offset:49152
    ds_read_b64_tr_b16 v[82:83], v49 offset:49664
    ds_read_b64_tr_b16 v[96:97], v50 offset:49152
    ds_read_b64_tr_b16 v[98:99], v50 offset:49664
    ds_read_b64_tr_b16 v[112:113], v51 offset:49152
    ds_read_b64_tr_b16 v[114:115], v51 offset:49664
    ds_read_b64_tr_b16 v[68:69], v48 offset:53248
    ds_read_b64_tr_b16 v[70:71], v48 offset:53760
    ds_read_b64_tr_b16 v[84:85], v49 offset:53248
    ds_read_b64_tr_b16 v[86:87], v49 offset:53760
    ds_read_b64_tr_b16 v[100:101], v50 offset:53248
    ds_read_b64_tr_b16 v[102:103], v50 offset:53760
    ds_read_b64_tr_b16 v[116:117], v51 offset:53248
    ds_read_b64_tr_b16 v[118:119], v51 offset:53760
    s_waitcnt lgkmcnt(0)
    ds_read_b64_tr_b16 v[72:73], v48 offset:57344
    ds_read_b64_tr_b16 v[74:75], v48 offset:57856
    ds_read_b64_tr_b16 v[88:89], v49 offset:57344
    ds_read_b64_tr_b16 v[90:91], v49 offset:57856
    ds_read_b64_tr_b16 v[104:105], v50 offset:57344
    ds_read_b64_tr_b16 v[106:107], v50 offset:57856
    ds_read_b64_tr_b16 v[120:121], v51 offset:57344
    ds_read_b64_tr_b16 v[122:123], v51 offset:57856
    ds_read_b64_tr_b16 v[76:77], v48 offset:61440
    ds_read_b64_tr_b16 v[78:79], v48 offset:61952
    ds_read_b64_tr_b16 v[92:93], v49 offset:61440
    ds_read_b64_tr_b16 v[94:95], v49 offset:61952
    ds_read_b64_tr_b16 v[108:109], v50 offset:61440
    ds_read_b64_tr_b16 v[110:111], v50 offset:61952
    ds_read_b64_tr_b16 v[124:125], v51 offset:61440
    ds_read_b64_tr_b16 v[126:127], v51 offset:61952
    s_waitcnt lgkmcnt(0)
    s_waitcnt vmcnt(12)
    ds_read_b64_tr_b16 v[128:129], v48 offset:32768
    ds_read_b64_tr_b16 v[130:131], v48 offset:33280
    ds_read_b64_tr_b16 v[144:145], v49 offset:32768
    ds_read_b64_tr_b16 v[146:147], v49 offset:33280
    ds_read_b64_tr_b16 v[160:161], v50 offset:32768
    ds_read_b64_tr_b16 v[162:163], v50 offset:33280
    ds_read_b64_tr_b16 v[176:177], v51 offset:32768
    ds_read_b64_tr_b16 v[178:179], v51 offset:33280
    s_waitcnt lgkmcnt(6)
    v_mfma_f32_16x16x32_bf16 v[192:195], v[128:131], v[20:23], 0
    s_waitcnt lgkmcnt(4)
    v_mfma_f32_16x16x32_bf16 v[196:199], v[144:147], v[20:23], 0
    s_waitcnt lgkmcnt(2)
    v_mfma_f32_16x16x32_bf16 v[200:203], v[160:163], v[20:23], 0
    s_waitcnt lgkmcnt(0)
    v_mfma_f32_16x16x32_bf16 v[204:207], v[176:179], v[20:23], 0
    s_waitcnt vmcnt(8)
    ds_read_b64_tr_b16 v[132:133], v48 offset:36864
    ds_read_b64_tr_b16 v[134:135], v48 offset:37376
    ds_read_b64_tr_b16 v[148:149], v49 offset:36864
    ds_read_b64_tr_b16 v[150:151], v49 offset:37376
    ds_read_b64_tr_b16 v[164:165], v50 offset:36864
    ds_read_b64_tr_b16 v[166:167], v50 offset:37376
    ds_read_b64_tr_b16 v[180:181], v51 offset:36864
    ds_read_b64_tr_b16 v[182:183], v51 offset:37376
    s_waitcnt lgkmcnt(6)
    v_mfma_f32_16x16x32_bf16 v[192:195], v[132:135], v[24:27], v[192:195]
    s_waitcnt lgkmcnt(4)
    v_mfma_f32_16x16x32_bf16 v[196:199], v[148:151], v[24:27], v[196:199]
    s_waitcnt lgkmcnt(2)
    v_mfma_f32_16x16x32_bf16 v[200:203], v[164:167], v[24:27], v[200:203]
    s_waitcnt lgkmcnt(0)
    v_mfma_f32_16x16x32_bf16 v[204:207], v[180:183], v[24:27], v[204:207]
    s_waitcnt vmcnt(4)
    ds_read_b64_tr_b16 v[136:137], v48 offset:40960
    ds_read_b64_tr_b16 v[138:139], v48 offset:41472
    ds_read_b64_tr_b16 v[152:153], v49 offset:40960
    ds_read_b64_tr_b16 v[154:155], v49 offset:41472
    ds_read_b64_tr_b16 v[168:169], v50 offset:40960
    ds_read_b64_tr_b16 v[170:171], v50 offset:41472
    ds_read_b64_tr_b16 v[184:185], v51 offset:40960
    ds_read_b64_tr_b16 v[186:187], v51 offset:41472
    s_waitcnt lgkmcnt(6)
    v_mfma_f32_16x16x32_bf16 v[192:195], v[136:139], v[28:31], v[192:195]
    s_waitcnt lgkmcnt(4)
    v_mfma_f32_16x16x32_bf16 v[196:199], v[152:155], v[28:31], v[196:199]
    s_waitcnt lgkmcnt(2)
    v_mfma_f32_16x16x32_bf16 v[200:203], v[168:171], v[28:31], v[200:203]
    s_waitcnt lgkmcnt(0)
    v_mfma_f32_16x16x32_bf16 v[204:207], v[184:187], v[28:31], v[204:207]
    s_waitcnt vmcnt(0)
    ds_read_b64_tr_b16 v[140:141], v48 offset:45056
    ds_read_b64_tr_b16 v[142:143], v48 offset:45568
    ds_read_b64_tr_b16 v[156:157], v49 offset:45056
    ds_read_b64_tr_b16 v[158:159], v49 offset:45568
    ds_read_b64_tr_b16 v[172:173], v50 offset:45056
    ds_read_b64_tr_b16 v[174:175], v50 offset:45568
    ds_read_b64_tr_b16 v[188:189], v51 offset:45056
    ds_read_b64_tr_b16 v[190:191], v51 offset:45568
    s_waitcnt lgkmcnt(6)
    v_mfma_f32_16x16x32_bf16 v[192:195], v[140:143], v[32:35], v[192:195]
    s_waitcnt lgkmcnt(4)
    v_mfma_f32_16x16x32_bf16 v[196:199], v[156:159], v[32:35], v[196:199]
    s_waitcnt lgkmcnt(2)
    v_mfma_f32_16x16x32_bf16 v[200:203], v[172:175], v[32:35], v[200:203]
    s_waitcnt lgkmcnt(0)
    v_mfma_f32_16x16x32_bf16 v[204:207], v[188:191], v[32:35], v[204:207]
    s_nop 7
    v_mov_b32_dpp v192, v196 quad_perm:[0,1,2,3] row_mask:0xf bank_mask:0x2
    v_mov_b32_dpp v193, v197 quad_perm:[0,1,2,3] row_mask:0xf bank_mask:0x2
    v_mov_b32_dpp v194, v198 quad_perm:[0,1,2,3] row_mask:0xf bank_mask:0x2
    v_mov_b32_dpp v195, v199 quad_perm:[0,1,2,3] row_mask:0xf bank_mask:0x2
    v_mov_b32_dpp v192, v200 quad_perm:[0,1,2,3] row_mask:0xf bank_mask:0x4
    v_mov_b32_dpp v193, v201 quad_perm:[0,1,2,3] row_mask:0xf bank_mask:0x4
    v_mov_b32_dpp v194, v202 quad_perm:[0,1,2,3] row_mask:0xf bank_mask:0x4
    v_mov_b32_dpp v195, v203 quad_perm:[0,1,2,3] row_mask:0xf bank_mask:0x4
    v_mov_b32_dpp v192, v204 quad_perm:[0,1,2,3] row_mask:0xf bank_mask:0x8
    v_mov_b32_dpp v193, v205 quad_perm:[0,1,2,3] row_mask:0xf bank_mask:0x8
    v_mov_b32_dpp v194, v206 quad_perm:[0,1,2,3] row_mask:0xf bank_mask:0x8
    v_mov_b32_dpp v195, v207 quad_perm:[0,1,2,3] row_mask:0xf bank_mask:0x8
    v_add_u32 v192, 0x80, v192
    v_add_u32 v193, 0x80, v193
    v_add_u32 v194, 0x80, v194
    v_add_u32 v195, 0x80, v195
    v_bfi_b32 v192, s73, v6, v192
    v_bfi_b32 v193, s73, v56, v193
    v_bfi_b32 v194, s73, v57, v194
    v_bfi_b32 v195, s73, v58, v195
    buffer_store_dwordx4 v[192:195], v59, s[52:55], s74 offen sc1
    s_branch L_og2
L_og1:
    s_waitcnt vmcnt(12)
    ds_read_b64_tr_b16 v[64:65], v48 offset:49152
    ds_read_b64_tr_b16 v[66:67], v48 offset:49664
    ds_read_b64_tr_b16 v[80:81], v49 offset:49152
    ds_read_b64_tr_b16 v[82:83], v49 offset:49664
    ds_read_b64_tr_b16 v[96:97], v50 offset:49152
    ds_read_b64_tr_b16 v[98:99], v50 offset:49664
    ds_read_b64_tr_b16 v[112:113], v51 offset:49152
    ds_read_b64_tr_b16 v[114:115], v51 offset:49664
    s_waitcnt vmcnt(8)
    ds_read_b64_tr_b16 v[68:69], v48 offset:53248
    ds_read_b64_tr_b16 v[70:71], v48 offset:53760
    ds_read_b64_tr_b16 v[84:85], v49 offset:53248
    ds_read_b64_tr_b16 v[86:87], v49 offset:53760
    ds_read_b64_tr_b16 v[100:101], v50 offset:53248
    ds_read_b64_tr_b16 v[102:103], v50 offset:53760
    ds_read_b64_tr_b16 v[116:117], v51 offset:53248
    ds_read_b64_tr_b16 v[118:119], v51 offset:53760
    s_waitcnt lgkmcnt(0)
    s_waitcnt vmcnt(4)
    ds_read_b64_tr_b16 v[72:73], v48 offset:57344
    ds_read_b64_tr_b16 v[74:75], v48 offset:57856
    ds_read_b64_tr_b16 v[88:89], v49 offset:57344
    ds_read_b64_tr_b16 v[90:91], v49 offset:57856
    ds_read_b64_tr_b16 v[104:105], v50 offset:57344
    ds_read_b64_tr_b16 v[106:107], v50 offset:57856
    ds_read_b64_tr_b16 v[120:121], v51 offset:57344
    ds_read_b64_tr_b16 v[122:123], v51 offset:57856
    s_waitcnt vmcnt(0)
    ds_read_b64_tr_b16 v[76:77], v48 offset:61440
    ds_read_b64_tr_b16 v[78:79], v48 offset:61952
    ds_read_b64_tr_b16 v[92:93], v49 offset:61440
    ds_read_b64_tr_b16 v[94:95], v49 offset:61952
    ds_read_b64_tr_b16 v[108:109], v50 offset:61440
    ds_read_b64_tr_b16 v[110:111], v50 offset:61952
    ds_read_b64_tr_b16 v[124:125], v51 offset:61440
    ds_read_b64_tr_b16 v[126:127], v51 offset:61952
    s_waitcnt lgkmcnt(0)
L_og2:
    v_and_b32 v14, 3, v3
    v_lshrrev_b32 v13, 2, v3
    v_lshlrev_b32 v12, 11, v14
    v_lshl_add_u32 v12, v13, 6, v12
    v_lshl_add_u32 v12, v2, 4, v12
    s_lshl_b32 s98, s18, 13
    s_add_u32 s98, s98, 266240
    s_mov_b32 s96, 0
    s_mov_b64 s[86:87], -1
    s_mov_b64 s[88:89], -1
L_opoll:
    s_mov_b64 exec, s[86:87]
    s_cbranch_execz L_osk0
    buffer_load_dwordx4 v[192:195], v12, s[52:55], s98 offen offset:0 sc1
    buffer_load_dwordx4 v[196:199], v12, s[52:55], s98 offen offset:256 sc1
    buffer_load_dwordx4 v[200:203], v12, s[52:55], s98 offen offset:512 sc1
    buffer_load_dwordx4 v[204:207], v12, s[52:55], s98 offen offset:768 sc1
L_osk0:
    s_mov_b64 exec, s[88:89]
    s_cbranch_execz L_osk1
    buffer_load_dwordx4 v[208:211], v12, s[52:55], s98 offen offset:1024 sc1
    buffer_load_dwordx4 v[212:215], v12, s[52:55], s98 offen offset:1280 sc1
    buffer_load_dwordx4 v[216:219], v12, s[52:55], s98 offen offset:1536 sc1
    buffer_load_dwordx4 v[220:223], v12, s[52:55], s98 offen offset:1792 sc1
L_osk1:
    s_mov_b64 exec, -1
    s_waitcnt vmcnt(0)
    v_xor_b32 v14, v6, v195
    v_xor_b32 v15, v6, v199
    v_xor_b32 v224, v6, v203
    v_xor_b32 v225, v6, v207
    v_or3_b32 v14, v14, v15, v224
    v_or_b32 v14, v14, v225
    v_cmp_ne_u32 s[86:87], 0, v14
    v_xor_b32 v14, v6, v211
    v_xor_b32 v15, v6, v215
    v_xor_b32 v224, v6, v219
    v_xor_b32 v225, v6, v223
    v_or3_b32 v14, v14, v15, v224
    v_or_b32 v14, v14, v225
    v_cmp_ne_u32 s[88:89], 0, v14
    s_or_b64 vcc, s[86:87], s[88:89]
    s_cbranch_scc0 L_opoll_done
    s_add_u32 s96, s96, 1
    s_cmp_lt_u32 s96, 0x400000
    s_cbranch_scc1 L_opoll
L_opoll_done:
    v_max_f32 v12, v194, v210
    v_sub_f32 v13, v194, v12
    v_sub_f32 v14, v210, v12
    v_mul_f32 v13, s20, v13
    v_mul_f32 v14, s20, v14
    v_exp_f32 v13, v13
    v_exp_f32 v14, v14
    s_nop 0
    v_mul_f32 v12, v198, v13
    v_fmac_f32 v12, v214, v14
    v_rcp_f32 v12, v12
    s_nop 0
    v_mul_f32 v13, v13, v12
    v_mul_f32 v14, v14, v12
    v_mul_f32 v192, v192, v13
    v_mul_f32 v193, v193, v13
    v_mul_f32 v196, v196, v13
    v_mul_f32 v197, v197, v13
    v_mul_f32 v200, v200, v13
    v_mul_f32 v201, v201, v13
    v_mul_f32 v204, v204, v13
    v_mul_f32 v205, v205, v13
    v_fmac_f32 v192, v208, v14
    v_fmac_f32 v193, v209, v14
    v_fmac_f32 v196, v212, v14
    v_fmac_f32 v197, v213, v14
    v_fmac_f32 v200, v216, v14
    v_fmac_f32 v201, v217, v14
    v_fmac_f32 v204, v220, v14
    v_fmac_f32 v205, v221, v14
    v_cvt_pk_bf16_f32 v224, v192, v193
    v_cvt_pk_bf16_f32 v225, v196, v197
    v_cvt_pk_bf16_f32 v226, v200, v201
    v_cvt_pk_bf16_f32 v227, v204, v205
    s_nop 1
    v_mov_b32_dpp v228, v224 row_ror:12 row_mask:0xf bank_mask:0xf
    v_mov_b32_dpp v229, v225 row_ror:12 row_mask:0xf bank_mask:0xf
    v_mov_b32_dpp v230, v226 row_ror:12 row_mask:0xf bank_mask:0xf
    v_mov_b32_dpp v231, v227 row_ror:12 row_mask:0xf bank_mask:0xf
    v_mov_b32_dpp v232, v224 row_ror:8 row_mask:0xf bank_mask:0xf
    v_mov_b32_dpp v233, v225 row_ror:8 row_mask:0xf bank_mask:0xf
    v_mov_b32_dpp v234, v226 row_ror:8 row_mask:0xf bank_mask:0xf
    v_mov_b32_dpp v235, v227 row_ror:8 row_mask:0xf bank_mask:0xf
    v_mov_b32_dpp v236, v224 row_ror:4 row_mask:0xf bank_mask:0xf
    v_mov_b32_dpp v237, v225 row_ror:4 row_mask:0xf bank_mask:0xf
    v_mov_b32_dpp v238, v226 row_ror:4 row_mask:0xf bank_mask:0xf
    v_mov_b32_dpp v239, v227 row_ror:4 row_mask:0xf bank_mask:0xf
    s_lshl_b32 s97, s25, 10
    s_add_u32 s97, s97, 4096
    v_mfma_f32_16x16x32_bf16 v[240:243], v[64:67], v[224:227], 0
    v_mfma_f32_16x16x32_bf16 v[244:247], v[84:87], v[224:227], 0
    v_mfma_f32_16x16x32_bf16 v[248:251], v[104:107], v[224:227], 0
    v_mfma_f32_16x16x32_bf16 v[252:255], v[124:127], v[224:227], 0
    v_mfma_f32_16x16x32_bf16 v[240:243], v[68:71], v[228:231], v[240:243]
    v_mfma_f32_16x16x32_bf16 v[244:247], v[88:91], v[228:231], v[244:247]
    v_mfma_f32_16x16x32_bf16 v[248:251], v[108:111], v[228:231], v[248:251]
    v_mfma_f32_16x16x32_bf16 v[252:255], v[112:115], v[228:231], v[252:255]
    v_mfma_f32_16x16x32_bf16 v[240:243], v[72:75], v[232:235], v[240:243]
    v_mfma_f32_16x16x32_bf16 v[244:247], v[92:95], v[232:235], v[244:247]
    v_mfma_f32_16x16x32_bf16 v[248:251], v[96:99], v[232:235], v[248:251]
    v_mfma_f32_16x16x32_bf16 v[252:255], v[116:119], v[232:235], v[252:255]
    v_mfma_f32_16x16x32_bf16 v[240:243], v[76:79], v[236:239], v[240:243]
    v_mfma_f32_16x16x32_bf16 v[244:247], v[80:83], v[236:239], v[244:247]
    v_mfma_f32_16x16x32_bf16 v[248:251], v[100:103], v[236:239], v[248:251]
    v_mfma_f32_16x16x32_bf16 v[252:255], v[120:123], v[236:239], v[252:255]
    v_lshrrev_b32 v12, 1, v1
    v_lshlrev_b32 v12, 13, v12
    v_and_b32 v13, 1, v1
    v_lshl_add_u32 v13, v13, 4, v12
    s_nop 3
    v_mov_b32_dpp v240, v244 quad_perm:[0,1,2,3] row_mask:0xf bank_mask:0x2
    v_mov_b32_dpp v241, v245 quad_perm:[0,1,2,3] row_mask:0xf bank_mask:0x2
    v_mov_b32_dpp v242, v246 quad_perm:[0,1,2,3] row_mask:0xf bank_mask:0x2
    v_mov_b32_dpp v243, v247 quad_perm:[0,1,2,3] row_mask:0xf bank_mask:0x2
    v_mov_b32_dpp v240, v248 quad_perm:[0,1,2,3] row_mask:0xf bank_mask:0x4
    v_mov_b32_dpp v241, v249 quad_perm:[0,1,2,3] row_mask:0xf bank_mask:0x4
    v_mov_b32_dpp v242, v250 quad_perm:[0,1,2,3] row_mask:0xf bank_mask:0x4
    v_mov_b32_dpp v243, v251 quad_perm:[0,1,2,3] row_mask:0xf bank_mask:0x4
    v_mov_b32_dpp v240, v252 quad_perm:[0,1,2,3] row_mask:0xf bank_mask:0x8
    v_mov_b32_dpp v241, v253 quad_perm:[0,1,2,3] row_mask:0xf bank_mask:0x8
    v_mov_b32_dpp v242, v254 quad_perm:[0,1,2,3] row_mask:0xf bank_mask:0x8
    v_mov_b32_dpp v243, v255 quad_perm:[0,1,2,3] row_mask:0xf bank_mask:0x8
    v_add_u32 v240, 0x80, v240
    v_add_u32 v241, 0x80, v241
    v_add_u32 v242, 0x80, v242
    v_add_u32 v243, 0x80, v243
    v_bfi_b32 v240, s73, v6, v240
    v_bfi_b32 v241, s73, v56, v241
    v_bfi_b32 v242, s73, v57, v242
    v_bfi_b32 v243, s73, v58, v243
    buffer_store_dwordx4 v[240:243], v59, s[52:55], s97 offen sc1
    v_mov_b32 v32, 0
    v_mov_b32 v33, 0
    v_mov_b32 v34, 0
    v_mov_b32 v35, 0
    s_mov_b32 s96, 0
    s_mov_b32 exec_lo, 0x3fffff
    s_mov_b32 exec_hi, 0x0
L_fw:
    buffer_load_dwordx4 v[32:35], v13, s[52:55], s19 offen sc1
    s_waitcnt vmcnt(0)
    v_xor_b32 v14, v32, v6
    v_bitop3_b32 v14, v14, v33, v56 bitop3:0xf6
    v_bitop3_b32 v14, v14, v34, v57 bitop3:0xf6
    v_bitop3_b32 v14, v14, v35, v58 bitop3:0xf6
    v_and_b32 v14, 0xff, v14
    v_cmp_ne_u32 vcc, 0, v14
    s_cbranch_vccz L_fd
    s_mov_b64 exec, vcc
    s_add_u32 s96, s96, 1
    s_cmp_lt_u32 s96, 0x400000
    s_cbranch_scc1 L_fw
L_fd:
    s_mov_b64 exec, -1
    buffer_load_dwordx4 v[200:203], v13, s[52:55], s22 offen sc1
    v_and_b32 v32, 0xffffff00, v32
    v_and_b32 v33, 0xffffff00, v33
    v_and_b32 v34, 0xffffff00, v34
    v_and_b32 v35, 0xffffff00, v35
    s_nop 1
    v_add_f32_dpp v192, v32, v32 quad_perm:[2,3,0,1] row_mask:0xf bank_mask:0xf
    v_add_f32_dpp v193, v33, v33 quad_perm:[2,3,0,1] row_mask:0xf bank_mask:0xf
    v_add_f32_dpp v194, v34, v34 quad_perm:[2,3,0,1] row_mask:0xf bank_mask:0xf
    v_add_f32_dpp v195, v35, v35 quad_perm:[2,3,0,1] row_mask:0xf bank_mask:0xf
    v_add_f32_dpp v32, v192, v192 row_ror:4 row_mask:0xf bank_mask:0xf
    v_add_f32_dpp v33, v193, v193 row_ror:4 row_mask:0xf bank_mask:0xf
    v_add_f32_dpp v34, v194, v194 row_ror:4 row_mask:0xf bank_mask:0xf
    v_add_f32_dpp v35, v195, v195 row_ror:4 row_mask:0xf bank_mask:0xf
    v_add_f32_dpp v192, v32, v32 row_ror:8 row_mask:0xf bank_mask:0xf
    v_add_f32_dpp v193, v33, v33 row_ror:8 row_mask:0xf bank_mask:0xf
    v_add_f32_dpp v194, v34, v34 row_ror:8 row_mask:0xf bank_mask:0xf
    v_add_f32_dpp v195, v35, v35 row_ror:8 row_mask:0xf bank_mask:0xf
    v_mov_b32 v32, v192
    v_mov_b32 v33, v193
    v_mov_b32 v34, v194
    v_mov_b32 v35, v195
    v_mov_b32 v192, v32
    v_mov_b32 v193, v33
    v_mov_b32 v194, v34
    v_mov_b32 v195, v35
    s_nop 1
    v_permlane16_swap_b32 v32, v192
    v_permlane16_swap_b32 v33, v193
    v_permlane16_swap_b32 v34, v194
    v_permlane16_swap_b32 v35, v195
    s_nop 1
    v_add_f32 v32, v32, v192
    v_add_f32 v33, v33, v193
    v_add_f32 v34, v34, v194
    v_add_f32 v35, v35, v195
    v_mov_b32 v192, v32
    v_mov_b32 v193, v33
    v_mov_b32 v194, v34
    v_mov_b32 v195, v35
    s_nop 1
    v_permlane32_swap_b32 v32, v192
    v_permlane32_swap_b32 v33, v193
    v_permlane32_swap_b32 v34, v194
    v_permlane32_swap_b32 v35, v195
    s_nop 1
    v_add_f32 v32, v32, v192
    v_add_f32 v33, v33, v193
    v_add_f32 v34, v34, v194
    v_add_f32 v35, v35, v195
    v_cvt_pk_bf16_f32 v32, v32, v32
    v_and_b32 v32, 0xffff0000, v32
    v_mul_f32 v32, v61, v32
    v_cvt_pk_bf16_f32 v32, v32, v32
    v_and_b32 v32, 0xffff0000, v32
    v_cvt_pk_bf16_f32 v33, v33, v33
    v_and_b32 v33, 0xffff0000, v33
    v_mul_f32 v33, v61, v33
    v_cvt_pk_bf16_f32 v33, v33, v33
    v_and_b32 v33, 0xffff0000, v33
    v_cvt_pk_bf16_f32 v34, v34, v34
    v_and_b32 v34, 0xffff0000, v34
    v_mul_f32 v34, v61, v34
    v_cvt_pk_bf16_f32 v34, v34, v34
    v_and_b32 v34, 0xffff0000, v34
    v_cvt_pk_bf16_f32 v35, v35, v35
    v_and_b32 v35, 0xffff0000, v35
    v_mul_f32 v35, v61, v35
    v_cvt_pk_bf16_f32 v35, v35, v35
    v_and_b32 v35, 0xffff0000, v35
    s_mov_b32 s96, 0
    s_branch L_poll1
L_poll:
    buffer_load_dwordx4 v[200:203], v13, s[52:55], s22 offen sc1
L_poll1:
    s_waitcnt vmcnt(0)
    v_xor_b32 v12, v200, v6
    v_bitop3_b32 v12, v12, v201, v56 bitop3:0xf6
    v_bitop3_b32 v12, v12, v202, v57 bitop3:0xf6
    v_bitop3_b32 v12, v12, v203, v58 bitop3:0xf6
    v_and_b32 v12, 0xff, v12
    v_cmp_ne_u32 vcc, 0, v12
    s_cbranch_vccz L_poll_done
    s_mov_b64 exec, vcc
    s_add_u32 s96, s96, 1
    s_cmp_lt_u32 s96, 0x400000
    s_cbranch_scc1 L_poll
L_poll_done:
    s_mov_b64 exec, -1
    v_and_b32 v200, 0xffffff00, v200
    v_and_b32 v201, 0xffffff00, v201
    v_and_b32 v202, 0xffffff00, v202
    v_and_b32 v203, 0xffffff00, v203
    s_nop 1
    v_add_f32_dpp v204, v200, v200 quad_perm:[2,3,0,1] row_mask:0xf bank_mask:0xf
    v_add_f32_dpp v205, v201, v201 quad_perm:[2,3,0,1] row_mask:0xf bank_mask:0xf
    v_add_f32_dpp v206, v202, v202 quad_perm:[2,3,0,1] row_mask:0xf bank_mask:0xf
    v_add_f32_dpp v207, v203, v203 quad_perm:[2,3,0,1] row_mask:0xf bank_mask:0xf
    v_add_f32_dpp v200, v204, v204 row_ror:4 row_mask:0xf bank_mask:0xf
    v_add_f32_dpp v201, v205, v205 row_ror:4 row_mask:0xf bank_mask:0xf
    v_add_f32_dpp v202, v206, v206 row_ror:4 row_mask:0xf bank_mask:0xf
    v_add_f32_dpp v203, v207, v207 row_ror:4 row_mask:0xf bank_mask:0xf
    v_add_f32_dpp v204, v200, v200 row_ror:8 row_mask:0xf bank_mask:0xf
    v_add_f32_dpp v205, v201, v201 row_ror:8 row_mask:0xf bank_mask:0xf
    v_add_f32_dpp v206, v202, v202 row_ror:8 row_mask:0xf bank_mask:0xf
    v_add_f32_dpp v207, v203, v203 row_ror:8 row_mask:0xf bank_mask:0xf
    v_mov_b32 v200, v204
    v_mov_b32 v201, v205
    v_mov_b32 v202, v206
    v_mov_b32 v203, v207
    v_mov_b32 v204, v200
    v_mov_b32 v205, v201
    v_mov_b32 v206, v202
    v_mov_b32 v207, v203
    s_nop 1
    v_permlane16_swap_b32 v200, v204
    v_permlane16_swap_b32 v201, v205
    v_permlane16_swap_b32 v202, v206
    v_permlane16_swap_b32 v203, v207
    s_nop 1
    v_add_f32 v200, v200, v204
    v_add_f32 v201, v201, v205
    v_add_f32 v202, v202, v206
    v_add_f32 v203, v203, v207
    v_mov_b32 v204, v200
    v_mov_b32 v205, v201
    v_mov_b32 v206, v202
    v_mov_b32 v207, v203
    s_nop 1
    v_permlane32_swap_b32 v200, v204
    v_permlane32_swap_b32 v201, v205
    v_permlane32_swap_b32 v202, v206
    v_permlane32_swap_b32 v203, v207
    s_nop 1
    v_add_f32 v200, v200, v204
    v_add_f32 v201, v201, v205
    v_add_f32 v202, v202, v206
    v_add_f32 v203, v203, v207
    v_cvt_pk_bf16_f32 v200, v200, v200
    v_and_b32 v200, 0xffff0000, v200
    v_mul_f32 v200, v0, v200
    v_cvt_pk_bf16_f32 v200, v200, v200
    v_and_b32 v200, 0xffff0000, v200
    v_add_f32 v200, v200, v32
    v_cvt_pk_bf16_f32 v201, v201, v201
    v_and_b32 v201, 0xffff0000, v201
    v_mul_f32 v201, v0, v201
    v_cvt_pk_bf16_f32 v201, v201, v201
    v_and_b32 v201, 0xffff0000, v201
    v_add_f32 v201, v201, v33
    v_cvt_pk_bf16_f32 v202, v202, v202
    v_and_b32 v202, 0xffff0000, v202
    v_mul_f32 v202, v0, v202
    v_cvt_pk_bf16_f32 v202, v202, v202
    v_and_b32 v202, 0xffff0000, v202
    v_add_f32 v202, v202, v34
    v_cvt_pk_bf16_f32 v203, v203, v203
    v_and_b32 v203, 0xffff0000, v203
    v_mul_f32 v203, v0, v203
    v_cvt_pk_bf16_f32 v203, v203, v203
    v_and_b32 v203, 0xffff0000, v203
    v_add_f32 v203, v203, v35
    v_cvt_pk_bf16_f32 v204, v200, v201
    v_cvt_pk_bf16_f32 v205, v202, v203
    s_lshl_b32 s97, s3, 4
    v_lshlrev_b32 v12, 3, v1
    s_mov_b32 exec_lo, 0x3
    s_mov_b32 exec_hi, 0x0
    buffer_store_dwordx2 v[204:205], v12, s[56:59], s97 offen
    s_cmp_lg_u32 s3, 0
    s_cbranch_scc1 L_nogen
    s_mov_b64 exec, 1
    buffer_store_dword v6, v5, s[52:55], 0 offen offset:0 sc1
L_nogen:
    s_mov_b64 exec, -1
L_finw:
    s_waitcnt lgkmcnt(0)
L_fin:
L_exit:
    s_endpgm
L_resc_6:
    s_nop 0
    v_max_f32_dpp v12, v16, v16 row_ror:4 row_mask:0xf bank_mask:0xf
    s_nop 1
    v_max_f32_dpp v13, v12, v12 row_ror:8 row_mask:0xf bank_mask:0xf
    s_nop 0
    v_readlane_b32 s97, v13, 0
    v_readlane_b32 s98, v13, 16
    v_readlane_b32 s99, v13, 32
    v_readlane_b32 s100, v13, 48
    s_nop 0
    v_max_f32 v13, s97, v10
    v_max_f32 v13, s98, v13
    v_max_f32 v13, s99, v13
    v_max_f32 v13, s100, v13
    v_sub_f32 v12, v10, v13
    v_mul_f32 v12, s20, v12
    v_exp_f32 v12, v12
    v_mov_b32 v10, v13
    v_mul_f32 v18, s20, v13
    v_mul_f32 v20, v20, v12
    v_mul_f32 v22, v22, v12
    v_mul_f32 v11, v11, v12
    s_branch L_back_6
L_resc_7:
    s_nop 0
    v_max_f32_dpp v12, v16, v16 row_ror:4 row_mask:0xf bank_mask:0xf
    s_nop 1
    v_max_f32_dpp v13, v12, v12 row_ror:8 row_mask:0xf bank_mask:0xf
    s_nop 0
    v_readlane_b32 s97, v13, 0
    v_readlane_b32 s98, v13, 16
    v_readlane_b32 s99, v13, 32
    v_readlane_b32 s100, v13, 48
    s_nop 0
    v_max_f32 v13, s97, v10
    v_max_f32 v13, s98, v13
    v_max_f32 v13, s99, v13
    v_max_f32 v13, s100, v13
    v_sub_f32 v12, v10, v13
    v_mul_f32 v12, s20, v12
    v_exp_f32 v12, v12
    v_mov_b32 v10, v13
    v_mul_f32 v18, s20, v13
    v_mul_f32 v20, v20, v12
    v_mul_f32 v22, v22, v12
    v_mul_f32 v11, v11, v12
    s_branch L_back_7
L_resc_8:
    s_nop 0
    v_max_f32_dpp v12, v16, v16 row_ror:4 row_mask:0xf bank_mask:0xf
    s_nop 1
    v_max_f32_dpp v13, v12, v12 row_ror:8 row_mask:0xf bank_mask:0xf
    s_nop 0
    v_readlane_b32 s97, v13, 0
    v_readlane_b32 s98, v13, 16
    v_readlane_b32 s99, v13, 32
    v_readlane_b32 s100, v13, 48
    s_nop 0
    v_max_f32 v13, s97, v10
    v_max_f32 v13, s98, v13
    v_max_f32 v13, s99, v13
    v_max_f32 v13, s100, v13
    v_sub_f32 v12, v10, v13
    v_mul_f32 v12, s20, v12
    v_exp_f32 v12, v12
    v_mov_b32 v10, v13
    v_mul_f32 v18, s20, v13
    v_mul_f32 v20, v20, v12
    v_mul_f32 v22, v22, v12
    v_mul_f32 v11, v11, v12
    s_branch L_back_8
L_resc_9:
    s_nop 0
    v_max_f32_dpp v12, v16, v16 row_ror:4 row_mask:0xf bank_mask:0xf
    s_nop 1
    v_max_f32_dpp v13, v12, v12 row_ror:8 row_mask:0xf bank_mask:0xf
    s_nop 0
    v_readlane_b32 s97, v13, 0
    v_readlane_b32 s98, v13, 16
    v_readlane_b32 s99, v13, 32
    v_readlane_b32 s100, v13, 48
    s_nop 0
    v_max_f32 v13, s97, v10
    v_max_f32 v13, s98, v13
    v_max_f32 v13, s99, v13
    v_max_f32 v13, s100, v13
    v_sub_f32 v12, v10, v13
    v_mul_f32 v12, s20, v12
    v_exp_f32 v12, v12
    v_mov_b32 v10, v13
    v_mul_f32 v18, s20, v13
    v_mul_f32 v20, v20, v12
    v_mul_f32 v22, v22, v12
    v_mul_f32 v11, v11, v12
    s_branch L_back_9
L_qp:
    s_setprio 3
    s_waitcnt lgkmcnt(0)
    s_mul_i32 s27, s26, 0x9e3779b1
    s_add_u32 s27, s27, 0x7f4a7c15
    v_mov_b32 v6, s27
    v_bfe_u32 v12, v1, 2, 2
    v_lshl_add_u32 v13, v2, 3, v12
    v_lshlrev_b32 v48, 7, v13
    v_lshrrev_b32 v12, 1, v12
    v_lshl_add_u32 v48, v12, 5, v48
    v_and_b32 v12, 1, v2
    v_lshl_add_u32 v48, v12, 6, v48
    v_and_b32 v12, 3, v1
    v_lshl_add_u32 v48, v12, 3, v48
    v_xor_b32 v49, 32, v48
    v_xor_b32 v50, 64, v48
    v_xor_b32 v51, 96, v48
    v_lshlrev_b32 v59, 8, v12
    v_lshrrev_b32 v12, 2, v3
    v_lshl_add_u32 v59, v12, 6, v59
    v_lshl_add_u32 v59, v2, 4, v59
    v_lshrrev_b32 v56, 8, v6
    v_lshrrev_b32 v57, 16, v6
    v_lshrrev_b32 v58, 24, v6
    s_movk_i32 s73, 0xff
    s_lshl_b32 s100, s25, 10
    s_add_u32 s100, s100, 528384
    v_and_b32 v12, 1, v2
    v_lshlrev_b32 v12, 11, v12
    v_lshrrev_b32 v13, 1, v2
    v_lshl_add_u32 v12, v13, 10, v12
    v_lshl_add_u32 v9, v3, 4, v12
    v_lshlrev_b32 v8, 7, v13
    v_lshl_add_u32 v8, v3, 3, v8
    s_waitcnt vmcnt(12)
    ds_read_b64_tr_b16 v[128:129], v48 offset:16384
    ds_read_b64_tr_b16 v[130:131], v48 offset:16896
    ds_read_b64_tr_b16 v[144:145], v49 offset:16384
    ds_read_b64_tr_b16 v[146:147], v49 offset:16896
    ds_read_b64_tr_b16 v[160:161], v50 offset:16384
    ds_read_b64_tr_b16 v[162:163], v50 offset:16896
    ds_read_b64_tr_b16 v[176:177], v51 offset:16384
    ds_read_b64_tr_b16 v[178:179], v51 offset:16896
    s_waitcnt lgkmcnt(6)
    v_mfma_f32_16x16x32_bf16 v[192:195], v[128:131], v[20:23], 0
    s_waitcnt lgkmcnt(4)
    v_mfma_f32_16x16x32_bf16 v[196:199], v[144:147], v[20:23], 0
    s_waitcnt lgkmcnt(2)
    v_mfma_f32_16x16x32_bf16 v[200:203], v[160:163], v[20:23], 0
    s_waitcnt lgkmcnt(0)
    v_mfma_f32_16x16x32_bf16 v[204:207], v[176:179], v[20:23], 0
    s_waitcnt vmcnt(8)
    ds_read_b64_tr_b16 v[132:133], v48 offset:20480
    ds_read_b64_tr_b16 v[134:135], v48 offset:20992
    ds_read_b64_tr_b16 v[148:149], v49 offset:20480
    ds_read_b64_tr_b16 v[150:151], v49 offset:20992
    ds_read_b64_tr_b16 v[164:165], v50 offset:20480
    ds_read_b64_tr_b16 v[166:167], v50 offset:20992
    ds_read_b64_tr_b16 v[180:181], v51 offset:20480
    ds_read_b64_tr_b16 v[182:183], v51 offset:20992
    s_waitcnt lgkmcnt(6)
    v_mfma_f32_16x16x32_bf16 v[192:195], v[132:135], v[24:27], v[192:195]
    s_waitcnt lgkmcnt(4)
    v_mfma_f32_16x16x32_bf16 v[196:199], v[148:151], v[24:27], v[196:199]
    s_waitcnt lgkmcnt(2)
    v_mfma_f32_16x16x32_bf16 v[200:203], v[164:167], v[24:27], v[200:203]
    s_waitcnt lgkmcnt(0)
    v_mfma_f32_16x16x32_bf16 v[204:207], v[180:183], v[24:27], v[204:207]
    s_waitcnt vmcnt(4)
    ds_read_b64_tr_b16 v[136:137], v48 offset:24576
    ds_read_b64_tr_b16 v[138:139], v48 offset:25088
    ds_read_b64_tr_b16 v[152:153], v49 offset:24576
    ds_read_b64_tr_b16 v[154:155], v49 offset:25088
    ds_read_b64_tr_b16 v[168:169], v50 offset:24576
    ds_read_b64_tr_b16 v[170:171], v50 offset:25088
    ds_read_b64_tr_b16 v[184:185], v51 offset:24576
    ds_read_b64_tr_b16 v[186:187], v51 offset:25088
    s_waitcnt lgkmcnt(6)
    v_mfma_f32_16x16x32_bf16 v[192:195], v[136:139], v[28:31], v[192:195]
    s_waitcnt lgkmcnt(4)
    v_mfma_f32_16x16x32_bf16 v[196:199], v[152:155], v[28:31], v[196:199]
    s_waitcnt lgkmcnt(2)
    v_mfma_f32_16x16x32_bf16 v[200:203], v[168:171], v[28:31], v[200:203]
    s_waitcnt lgkmcnt(0)
    v_mfma_f32_16x16x32_bf16 v[204:207], v[184:187], v[28:31], v[204:207]
    s_waitcnt vmcnt(0)
    ds_read_b64_tr_b16 v[140:141], v48 offset:28672
    ds_read_b64_tr_b16 v[142:143], v48 offset:29184
    ds_read_b64_tr_b16 v[156:157], v49 offset:28672
    ds_read_b64_tr_b16 v[158:159], v49 offset:29184
    ds_read_b64_tr_b16 v[172:173], v50 offset:28672
    ds_read_b64_tr_b16 v[174:175], v50 offset:29184
    ds_read_b64_tr_b16 v[188:189], v51 offset:28672
    ds_read_b64_tr_b16 v[190:191], v51 offset:29184
    s_waitcnt lgkmcnt(6)
    v_mfma_f32_16x16x32_bf16 v[192:195], v[140:143], v[32:35], v[192:195]
    s_waitcnt lgkmcnt(4)
    v_mfma_f32_16x16x32_bf16 v[196:199], v[156:159], v[32:35], v[196:199]
    s_waitcnt lgkmcnt(2)
    v_mfma_f32_16x16x32_bf16 v[200:203], v[172:175], v[32:35], v[200:203]
    s_waitcnt lgkmcnt(0)
    v_mfma_f32_16x16x32_bf16 v[204:207], v[188:191], v[32:35], v[204:207]
    s_nop 7
    v_mov_b32_dpp v192, v196 quad_perm:[0,1,2,3] row_mask:0xf bank_mask:0x2
    v_mov_b32_dpp v193, v197 quad_perm:[0,1,2,3] row_mask:0xf bank_mask:0x2
    v_mov_b32_dpp v194, v198 quad_perm:[0,1,2,3] row_mask:0xf bank_mask:0x2
    v_mov_b32_dpp v195, v199 quad_perm:[0,1,2,3] row_mask:0xf bank_mask:0x2
    v_mov_b32_dpp v192, v200 quad_perm:[0,1,2,3] row_mask:0xf bank_mask:0x4
    v_mov_b32_dpp v193, v201 quad_perm:[0,1,2,3] row_mask:0xf bank_mask:0x4
    v_mov_b32_dpp v194, v202 quad_perm:[0,1,2,3] row_mask:0xf bank_mask:0x4
    v_mov_b32_dpp v195, v203 quad_perm:[0,1,2,3] row_mask:0xf bank_mask:0x4
    v_mov_b32_dpp v192, v204 quad_perm:[0,1,2,3] row_mask:0xf bank_mask:0x8
    v_mov_b32_dpp v193, v205 quad_perm:[0,1,2,3] row_mask:0xf bank_mask:0x8
    v_mov_b32_dpp v194, v206 quad_perm:[0,1,2,3] row_mask:0xf bank_mask:0x8
    v_mov_b32_dpp v195, v207 quad_perm:[0,1,2,3] row_mask:0xf bank_mask:0x8
    v_add_u32 v192, 0x80, v192
    v_add_u32 v193, 0x80, v193
    v_add_u32 v194, 0x80, v194
    v_add_u32 v195, 0x80, v195
    v_bfi_b32 v192, s73, v6, v192
    v_bfi_b32 v193, s73, v56, v193
    v_bfi_b32 v194, s73, v57, v194
    v_bfi_b32 v195, s73, v58, v195
    buffer_store_dwordx4 v[192:195], v59, s[52:55], s100 offen sc1
    s_lshl_b32 s100, s18, 13
    s_lshl_b32 s99, s17, 8
    s_add_u32 s100, s100, s99
    s_add_u32 s99, s100, 528384
    s_add_u32 s100, s100, 532480
    s_mov_b32 s96, 0
L_qw:
    buffer_load_dwordx4 v[128:131], v9, s[52:55], s99 offen sc1
    buffer_load_dwordx4 v[132:135], v9, s[52:55], s100 offen sc1
    s_waitcnt vmcnt(0)
    v_xor_b32 v12, v128, v6
    v_bitop3_b32 v12, v12, v129, v56 bitop3:0xf6
    v_bitop3_b32 v12, v12, v130, v57 bitop3:0xf6
    v_bitop3_b32 v12, v12, v131, v58 bitop3:0xf6
    v_bitop3_b32 v12, v12, v132, v6 bitop3:0xf6
    v_bitop3_b32 v12, v12, v133, v56 bitop3:0xf6
    v_bitop3_b32 v12, v12, v134, v57 bitop3:0xf6
    v_bitop3_b32 v12, v12, v135, v58 bitop3:0xf6
    v_and_b32 v12, 0xff, v12
    v_cmp_ne_u32 vcc, 0, v12
    s_cbranch_vccz L_qd
    s_mov_b64 exec, vcc
    s_add_u32 s96, s96, 1
    s_cmp_lt_u32 s96, 0x400000
    s_cbranch_scc1 L_qw
L_qd:
    s_mov_b64 exec, -1
    s_mov_b32 s97, 24
    s_xor_b32 s5, s97, s66
    s_and_b32 s94, s5, 0x1
    s_lshl_b32 s94, s94, 13
    s_and_b32 s6, s5, 0x2
    s_lshl_b32 s6, s6, 10
    s_or_b32 s94, s94, s6
    s_and_b32 s6, s5, 0x4
    s_lshl_b32 s6, s6, 8
    s_or_b32 s94, s94, s6
    s_and_b32 s6, s5, 0x8
    s_lshl_b32 s6, s6, 13
    s_or_b32 s94, s94, s6
    s_and_b32 s6, s5, 0x10
    s_lshl_b32 s6, s6, 8
    s_or_b32 s94, s94, s6
    s_and_b32 s6, s5, 0xe0
    s_lshl_b32 s6, s6, 12
    s_or_b32 s94, s94, s6
    buffer_load_dwordx4 v[64:67], v4, s[32:35], s94 offen offset:0 nt
    buffer_load_dwordx4 v[68:71], v4, s[32:35], s94 offen offset:256 nt
    buffer_load_dwordx4 v[72:75], v4, s[32:35], s94 offen offset:512 nt
    buffer_load_dwordx4 v[76:79], v4, s[32:35], s94 offen offset:768 nt
    buffer_load_dwordx4 v[80:83], v0, s[36:39], s94 offen offset:0 nt
    buffer_load_dwordx4 v[84:87], v0, s[36:39], s94 offen offset:256 nt
    buffer_load_dwordx4 v[88:91], v0, s[36:39], s94 offen offset:512 nt
    buffer_load_dwordx4 v[92:95], v0, s[36:39], s94 offen offset:768 nt
    s_mov_b32 s97, 25
    s_xor_b32 s5, s97, s66
    s_and_b32 s94, s5, 0x1
    s_lshl_b32 s94, s94, 13
    s_and_b32 s6, s5, 0x2
    s_lshl_b32 s6, s6, 10
    s_or_b32 s94, s94, s6
    s_and_b32 s6, s5, 0x4
    s_lshl_b32 s6, s6, 8
    s_or_b32 s94, s94, s6
    s_and_b32 s6, s5, 0x8
    s_lshl_b32 s6, s6, 13
    s_or_b32 s94, s94, s6
    s_and_b32 s6, s5, 0x10
    s_lshl_b32 s6, s6, 8
    s_or_b32 s94, s94, s6
    s_and_b32 s6, s5, 0xe0
    s_lshl_b32 s6, s6, 12
    s_or_b32 s94, s94, s6
    buffer_load_dwordx4 v[96:99], v4, s[32:35], s94 offen offset:0 nt
    buffer_load_dwordx4 v[100:103], v4, s[32:35], s94 offen offset:256 nt
    buffer_load_dwordx4 v[104:107], v4, s[32:35], s94 offen offset:512 nt
    buffer_load_dwordx4 v[108:111], v4, s[32:35], s94 offen offset:768 nt
    buffer_load_dwordx4 v[112:115], v0, s[36:39], s94 offen offset:0 nt
    buffer_load_dwordx4 v[116:119], v0, s[36:39], s94 offen offset:256 nt
    buffer_load_dwordx4 v[120:123], v0, s[36:39], s94 offen offset:512 nt
    buffer_load_dwordx4 v[124:127], v0, s[36:39], s94 offen offset:768 nt
    v_and_b32 v128, 0xffffff00, v128
    v_and_b32 v129, 0xffffff00, v129
    v_and_b32 v130, 0xffffff00, v130
    v_and_b32 v131, 0xffffff00, v131
    v_and_b32 v132, 0xffffff00, v132
    v_and_b32 v133, 0xffffff00, v133
    v_and_b32 v134, 0xffffff00, v134
    v_and_b32 v135, 0xffffff00, v135
    v_add_f32 v128, v128, v132
    v_add_f32 v129, v129, v133
    v_add_f32 v130, v130, v134
    v_add_f32 v131, v131, v135
    v_mov_b32 v132, v128
    v_mov_b32 v133, v129
    v_mov_b32 v134, v130
    v_mov_b32 v135, v131
    s_nop 1
    v_permlane16_swap_b32 v128, v132
    v_permlane16_swap_b32 v129, v133
    v_permlane16_swap_b32 v130, v134
    v_permlane16_swap_b32 v131, v135
    s_nop 1
    v_add_f32 v128, v128, v132
    v_add_f32 v129, v129, v133
    v_add_f32 v130, v130, v134
    v_add_f32 v131, v131, v135
    v_cvt_pk_bf16_f32 v14, v128, v129
    v_cvt_pk_bf16_f32 v15, v130, v131
    s_mov_b32 exec_lo, 0xffff
    s_mov_b32 exec_hi, 0xffff
    ds_write_b64 v8, v[14:15] offset:0
    s_mov_b64 exec, 1
    v_mov_b32 v14, 26
    v_mov_b32 v15, 1
    s_waitcnt lgkmcnt(0)
    ds_write_b64 v5, v[14:15] offset:8256
    s_mov_b64 exec, -1
    s_waitcnt lgkmcnt(0)
    s_setprio 0
    s_branch L_qgo
L_svc:
    s_setprio 3
    s_waitcnt lgkmcnt(0)
    s_mul_i32 s27, s26, 0x9e3779b1
    s_add_u32 s27, s27, 0x7f4a7c15
    v_mov_b32 v6, s27
    s_cmp_lg_u32 s66, 0
    s_cbranch_scc1 L_noinit
    v_mov_b32 v12, 0
    v_mov_b32 v13, s27
    s_mov_b64 exec, 1
    buffer_store_dwordx2 v[12:13], v5, s[52:55], s101 offen sc1
    s_mov_b64 exec, -1
L_noinit:
    v_lshrrev_b32 v60, 3, v1
    v_bfe_u32 v12, v1, 4, 1
    v_lshlrev_b32 v12, 1, v12
    v_and_b32 v13, 7, v1
    v_xor_b32 v12, v12, v13
    v_lshlrev_b32 v52, 4, v12
    v_xor_b32 v53, 64, v52
    v_bfe_u32 v12, v1, 2, 2
    v_lshl_add_u32 v13, v2, 3, v12
    v_lshlrev_b32 v48, 7, v13
    v_lshrrev_b32 v12, 1, v12
    v_lshl_add_u32 v48, v12, 5, v48
    v_and_b32 v12, 1, v2
    v_lshl_add_u32 v48, v12, 6, v48
    v_and_b32 v12, 3, v1
    v_lshl_add_u32 v48, v12, 3, v48
    v_xor_b32 v49, 32, v48
    v_xor_b32 v50, 64, v48
    v_xor_b32 v51, 96, v48
    v_lshlrev_b32 v59, 8, v12
    v_lshrrev_b32 v12, 2, v3
    v_lshl_add_u32 v59, v12, 6, v59
    v_lshl_add_u32 v59, v2, 4, v59
    v_lshrrev_b32 v56, 8, v6
    v_lshrrev_b32 v57, 16, v6
    v_lshrrev_b32 v58, 24, v6
    s_movk_i32 s73, 0xff
    s_cmp_ge_u32 s3, 176
    s_cbranch_scc1 L_s1_end
    s_lshr_b32 s99, s3, 3
    s_bfe_u32 s100, s3, 0x20001
    v_and_b32 v12, 3, v3
    v_lshlrev_b32 v12, 10, v12
    v_lshl_add_u32 v12, v2, 4, v12
    s_lshl_b32 s97, s100, 8
    buffer_load_dwordx4 v[20:23], v12, s[48:51], s97 offen offset:0
    buffer_load_dwordx4 v[24:27], v12, s[48:51], s97 offen offset:64
    buffer_load_dwordx4 v[28:31], v12, s[48:51], s97 offen offset:128
    buffer_load_dwordx4 v[32:35], v12, s[48:51], s97 offen offset:192
    s_mul_i32 s94, s100, 352256
    s_lshl_b32 s97, s99, 7
    s_add_u32 s94, s94, s97
    s_movk_i32 s97, 2752
    v_mad_u32_u24 v54, v60, s97, v52
    v_mad_u32_u24 v55, v60, s97, v53
    s_mov_b32 m0, 32768
    s_nop 0
    buffer_load_dwordx4 v54, s[68:71], s94 offen nt lds
    s_mov_b32 m0, 33792
    s_add_u32 s94, s94, 22016
    buffer_load_dwordx4 v55, s[68:71], s94 offen nt lds
    s_mov_b32 m0, 34816
    s_add_u32 s94, s94, 22016
    buffer_load_dwordx4 v54, s[68:71], s94 offen nt lds
    s_mov_b32 m0, 35840
    s_add_u32 s94, s94, 22016
    buffer_load_dwordx4 v55, s[68:71], s94 offen nt lds
    s_mov_b32 m0, 36864
    s_add_u32 s94, s94, 22016
    buffer_load_dwordx4 v54, s[68:71], s94 offen nt lds
    s_mov_b32 m0, 37888
    s_add_u32 s94, s94, 22016
    buffer_load_dwordx4 v55, s[68:71], s94 offen nt lds
    s_mov_b32 m0, 38912
    s_add_u32 s94, s94, 22016
    buffer_load_dwordx4 v54, s[68:71], s94 offen nt lds
    s_mov_b32 m0, 39936
    s_add_u32 s94, s94, 22016
    buffer_load_dwordx4 v55, s[68:71], s94 offen nt lds
    s_mov_b32 m0, 40960
    s_add_u32 s94, s94, 22016
    buffer_load_dwordx4 v54, s[68:71], s94 offen nt lds
    s_mov_b32 m0, 41984
    s_add_u32 s94, s94, 22016
    buffer_load_dwordx4 v55, s[68:71], s94 offen nt lds
    s_mov_b32 m0, 43008
    s_add_u32 s94, s94, 22016
    buffer_load_dwordx4 v54, s[68:71], s94 offen nt lds
    s_mov_b32 m0, 44032
    s_add_u32 s94, s94, 22016
    buffer_load_dwordx4 v55, s[68:71], s94 offen nt lds
    s_mov_b32 m0, 45056
    s_add_u32 s94, s94, 22016
    buffer_load_dwordx4 v54, s[68:71], s94 offen nt lds
    s_mov_b32 m0, 46080
    s_add_u32 s94, s94, 22016
    buffer_load_dwordx4 v55, s[68:71], s94 offen nt lds
    s_mov_b32 m0, 47104
    s_add_u32 s94, s94, 22016
    buffer_load_dwordx4 v54, s[68:71], s94 offen nt lds
    s_mov_b32 m0, 48128
    s_add_u32 s94, s94, 22016
    buffer_load_dwordx4 v55, s[68:71], s94 offen nt lds
    s_lshl_b32 s75, s3, 10
    s_add_u32 s75, s75, 790528
    s_waitcnt vmcnt(12)
    ds_read_b64_tr_b16 v[128:129], v48 offset:32768
    ds_read_b64_tr_b16 v[130:131], v48 offset:33280
    ds_read_b64_tr_b16 v[144:145], v49 offset:32768
    ds_read_b64_tr_b16 v[146:147], v49 offset:33280
    ds_read_b64_tr_b16 v[160:161], v50 offset:32768
    ds_read_b64_tr_b16 v[162:163], v50 offset:33280
    ds_read_b64_tr_b16 v[176:177], v51 offset:32768
    ds_read_b64_tr_b16 v[178:179], v51 offset:33280
    s_waitcnt lgkmcnt(6)
    v_mfma_f32_16x16x32_bf16 v[192:195], v[128:131], v[20:23], 0
    s_waitcnt lgkmcnt(4)
    v_mfma_f32_16x16x32_bf16 v[196:199], v[144:147], v[20:23], 0
    s_waitcnt lgkmcnt(2)
    v_mfma_f32_16x16x32_bf16 v[200:203], v[160:163], v[20:23], 0
    s_waitcnt lgkmcnt(0)
    v_mfma_f32_16x16x32_bf16 v[204:207], v[176:179], v[20:23], 0
    s_waitcnt vmcnt(8)
    ds_read_b64_tr_b16 v[132:133], v48 offset:36864
    ds_read_b64_tr_b16 v[134:135], v48 offset:37376
    ds_read_b64_tr_b16 v[148:149], v49 offset:36864
    ds_read_b64_tr_b16 v[150:151], v49 offset:37376
    ds_read_b64_tr_b16 v[164:165], v50 offset:36864
    ds_read_b64_tr_b16 v[166:167], v50 offset:37376
    ds_read_b64_tr_b16 v[180:181], v51 offset:36864
    ds_read_b64_tr_b16 v[182:183], v51 offset:37376
    s_waitcnt lgkmcnt(6)
    v_mfma_f32_16x16x32_bf16 v[192:195], v[132:135], v[24:27], v[192:195]
    s_waitcnt lgkmcnt(4)
    v_mfma_f32_16x16x32_bf16 v[196:199], v[148:151], v[24:27], v[196:199]
    s_waitcnt lgkmcnt(2)
    v_mfma_f32_16x16x32_bf16 v[200:203], v[164:167], v[24:27], v[200:203]
    s_waitcnt lgkmcnt(0)
    v_mfma_f32_16x16x32_bf16 v[204:207], v[180:183], v[24:27], v[204:207]
    s_waitcnt vmcnt(4)
    ds_read_b64_tr_b16 v[136:137], v48 offset:40960
    ds_read_b64_tr_b16 v[138:139], v48 offset:41472
    ds_read_b64_tr_b16 v[152:153], v49 offset:40960
    ds_read_b64_tr_b16 v[154:155], v49 offset:41472
    ds_read_b64_tr_b16 v[168:169], v50 offset:40960
    ds_read_b64_tr_b16 v[170:171], v50 offset:41472
    ds_read_b64_tr_b16 v[184:185], v51 offset:40960
    ds_read_b64_tr_b16 v[186:187], v51 offset:41472
    s_waitcnt lgkmcnt(6)
    v_mfma_f32_16x16x32_bf16 v[192:195], v[136:139], v[28:31], v[192:195]
    s_waitcnt lgkmcnt(4)
    v_mfma_f32_16x16x32_bf16 v[196:199], v[152:155], v[28:31], v[196:199]
    s_waitcnt lgkmcnt(2)
    v_mfma_f32_16x16x32_bf16 v[200:203], v[168:171], v[28:31], v[200:203]
    s_waitcnt lgkmcnt(0)
    v_mfma_f32_16x16x32_bf16 v[204:207], v[184:187], v[28:31], v[204:207]
    s_waitcnt vmcnt(0)
    ds_read_b64_tr_b16 v[140:141], v48 offset:45056
    ds_read_b64_tr_b16 v[142:143], v48 offset:45568
    ds_read_b64_tr_b16 v[156:157], v49 offset:45056
    ds_read_b64_tr_b16 v[158:159], v49 offset:45568
    ds_read_b64_tr_b16 v[172:173], v50 offset:45056
    ds_read_b64_tr_b16 v[174:175], v50 offset:45568
    ds_read_b64_tr_b16 v[188:189], v51 offset:45056
    ds_read_b64_tr_b16 v[190:191], v51 offset:45568
    s_waitcnt lgkmcnt(6)
    v_mfma_f32_16x16x32_bf16 v[192:195], v[140:143], v[32:35], v[192:195]
    s_waitcnt lgkmcnt(4)
    v_mfma_f32_16x16x32_bf16 v[196:199], v[156:159], v[32:35], v[196:199]
    s_waitcnt lgkmcnt(2)
    v_mfma_f32_16x16x32_bf16 v[200:203], v[172:175], v[32:35], v[200:203]
    s_waitcnt lgkmcnt(0)
    v_mfma_f32_16x16x32_bf16 v[204:207], v[188:191], v[32:35], v[204:207]
    s_nop 7
    v_mov_b32_dpp v192, v196 quad_perm:[0,1,2,3] row_mask:0xf bank_mask:0x2
    v_mov_b32_dpp v193, v197 quad_perm:[0,1,2,3] row_mask:0xf bank_mask:0x2
    v_mov_b32_dpp v194, v198 quad_perm:[0,1,2,3] row_mask:0xf bank_mask:0x2
    v_mov_b32_dpp v195, v199 quad_perm:[0,1,2,3] row_mask:0xf bank_mask:0x2
    v_mov_b32_dpp v192, v200 quad_perm:[0,1,2,3] row_mask:0xf bank_mask:0x4
    v_mov_b32_dpp v193, v201 quad_perm:[0,1,2,3] row_mask:0xf bank_mask:0x4
    v_mov_b32_dpp v194, v202 quad_perm:[0,1,2,3] row_mask:0xf bank_mask:0x4
    v_mov_b32_dpp v195, v203 quad_perm:[0,1,2,3] row_mask:0xf bank_mask:0x4
    v_mov_b32_dpp v192, v204 quad_perm:[0,1,2,3] row_mask:0xf bank_mask:0x8
    v_mov_b32_dpp v193, v205 quad_perm:[0,1,2,3] row_mask:0xf bank_mask:0x8
    v_mov_b32_dpp v194, v206 quad_perm:[0,1,2,3] row_mask:0xf bank_mask:0x8
    v_mov_b32_dpp v195, v207 quad_perm:[0,1,2,3] row_mask:0xf bank_mask:0x8
    v_add_u32 v192, 0x80, v192
    v_add_u32 v193, 0x80, v193
    v_add_u32 v194, 0x80, v194
    v_add_u32 v195, 0x80, v195
    v_bfi_b32 v192, s73, v6, v192
    v_bfi_b32 v193, s73, v56, v193
    v_bfi_b32 v194, s73, v57, v194
    v_bfi_b32 v195, s73, v58, v195
    buffer_store_dwordx4 v[192:195], v59, s[52:55], s75 offen sc1
L_s1_end:
    s_cmp_lt_u32 s3, 168
    s_cbranch_scc1 L_s2_end
    s_sub_u32 s99, s3, 168
    s_lshr_b32 s99, s99, 3
    s_cmp_eq_u32 s99, 10
    s_cselect_b32 s86, 0xff00ff00, 0
    s_mov_b32 s87, s86
    s_lshl_b32 s99, s99, 14
    s_add_u32 s99, s99, 790528
    v_mov_b32 v12, 0
L_g1:
    ds_read_b64 v[14:15], v12 offset:8256
    s_waitcnt lgkmcnt(0)
    v_readfirstlane_b32 s97, v15
    v_readfirstlane_b32 s98, v14
    s_cmp_eq_u32 s97, 0
    s_cselect_b32 s98, 0, s98
    s_cmp_ge_u32 s98, 40
    s_cbranch_scc1 L_gd1
    s_sleep 4
    s_branch L_g1
L_gd1:
    s_mov_b32 s96, 0
L_pw:
    s_add_u32 s97, s99, 0
    buffer_load_dwordx4 v[192:195], v5, s[52:55], s97 offen offset:0 sc1
    buffer_load_dwordx4 v[208:211], v5, s[52:55], s97 offen offset:1024 sc1
    buffer_load_dwordx4 v[196:199], v5, s[52:55], s97 offen offset:2048 sc1
    buffer_load_dwordx4 v[212:215], v5, s[52:55], s97 offen offset:3072 sc1
    s_add_u32 s97, s99, 4096
    buffer_load_dwordx4 v[200:203], v5, s[52:55], s97 offen offset:0 sc1
    buffer_load_dwordx4 v[216:219], v5, s[52:55], s97 offen offset:1024 sc1
    buffer_load_dwordx4 v[204:207], v5, s[52:55], s97 offen offset:2048 sc1
    buffer_load_dwordx4 v[220:223], v5, s[52:55], s97 offen offset:3072 sc1
    s_add_u32 s97, s99, 8192
    buffer_load_dwordx4 v[224:227], v5, s[52:55], s97 offen offset:0 sc1
    buffer_load_dwordx4 v[240:243], v5, s[52:55], s97 offen offset:1024 sc1
    buffer_load_dwordx4 v[228:231], v5, s[52:55], s97 offen offset:2048 sc1
    buffer_load_dwordx4 v[244:247], v5, s[52:55], s97 offen offset:3072 sc1
    s_add_u32 s97, s99, 12288
    buffer_load_dwordx4 v[232:235], v5, s[52:55], s97 offen offset:0 sc1
    buffer_load_dwordx4 v[248:251], v5, s[52:55], s97 offen offset:1024 sc1
    buffer_load_dwordx4 v[236:239], v5, s[52:55], s97 offen offset:2048 sc1
    buffer_load_dwordx4 v[252:255], v5, s[52:55], s97 offen offset:3072 sc1
    s_waitcnt vmcnt(0)
    v_xor_b32 v14, v192, v6
    v_bitop3_b32 v14, v14, v193, v56 bitop3:0xf6
    v_bitop3_b32 v14, v14, v194, v57 bitop3:0xf6
    v_bitop3_b32 v14, v14, v195, v58 bitop3:0xf6
    v_bitop3_b32 v14, v14, v196, v6 bitop3:0xf6
    v_bitop3_b32 v14, v14, v197, v56 bitop3:0xf6
    v_bitop3_b32 v14, v14, v198, v57 bitop3:0xf6
    v_bitop3_b32 v14, v14, v199, v58 bitop3:0xf6
    v_bitop3_b32 v14, v14, v200, v6 bitop3:0xf6
    v_bitop3_b32 v14, v14, v201, v56 bitop3:0xf6
    v_bitop3_b32 v14, v14, v202, v57 bitop3:0xf6
    v_bitop3_b32 v14, v14, v203, v58 bitop3:0xf6
    v_bitop3_b32 v14, v14, v204, v6 bitop3:0xf6
    v_bitop3_b32 v14, v14, v205, v56 bitop3:0xf6
    v_bitop3_b32 v14, v14, v206, v57 bitop3:0xf6
    v_bitop3_b32 v14, v14, v207, v58 bitop3:0xf6
    v_bitop3_b32 v14, v14, v208, v6 bitop3:0xf6
    v_bitop3_b32 v14, v14, v209, v56 bitop3:0xf6
    v_bitop3_b32 v14, v14, v210, v57 bitop3:0xf6
    v_bitop3_b32 v14, v14, v211, v58 bitop3:0xf6
    v_bitop3_b32 v14, v14, v212, v6 bitop3:0xf6
    v_bitop3_b32 v14, v14, v213, v56 bitop3:0xf6
    v_bitop3_b32 v14, v14, v214, v57 bitop3:0xf6
    v_bitop3_b32 v14, v14, v215, v58 bitop3:0xf6
    v_bitop3_b32 v14, v14, v216, v6 bitop3:0xf6
    v_bitop3_b32 v14, v14, v217, v56 bitop3:0xf6
    v_bitop3_b32 v14, v14, v218, v57 bitop3:0xf6
    v_bitop3_b32 v14, v14, v219, v58 bitop3:0xf6
    v_bitop3_b32 v14, v14, v220, v6 bitop3:0xf6
    v_bitop3_b32 v14, v14, v221, v56 bitop3:0xf6
    v_bitop3_b32 v14, v14, v222, v57 bitop3:0xf6
    v_bitop3_b32 v14, v14, v223, v58 bitop3:0xf6
    v_bitop3_b32 v14, v14, v224, v6 bitop3:0xf6
    v_bitop3_b32 v14, v14, v225, v56 bitop3:0xf6
    v_bitop3_b32 v14, v14, v226, v57 bitop3:0xf6
    v_bitop3_b32 v14, v14, v227, v58 bitop3:0xf6
    v_bitop3_b32 v14, v14, v228, v6 bitop3:0xf6
    v_bitop3_b32 v14, v14, v229, v56 bitop3:0xf6
    v_bitop3_b32 v14, v14, v230, v57 bitop3:0xf6
    v_bitop3_b32 v14, v14, v231, v58 bitop3:0xf6
    v_bitop3_b32 v14, v14, v232, v6 bitop3:0xf6
    v_bitop3_b32 v14, v14, v233, v56 bitop3:0xf6
    v_bitop3_b32 v14, v14, v234, v57 bitop3:0xf6
    v_bitop3_b32 v14, v14, v235, v58 bitop3:0xf6
    v_bitop3_b32 v14, v14, v236, v6 bitop3:0xf6
    v_bitop3_b32 v14, v14, v237, v56 bitop3:0xf6
    v_bitop3_b32 v14, v14, v238, v57 bitop3:0xf6
    v_bitop3_b32 v14, v14, v239, v58 bitop3:0xf6
    v_bitop3_b32 v14, v14, v240, v6 bitop3:0xf6
    v_bitop3_b32 v14, v14, v241, v56 bitop3:0xf6
    v_bitop3_b32 v14, v14, v242, v57 bitop3:0xf6
    v_bitop3_b32 v14, v14, v243, v58 bitop3:0xf6
    v_bitop3_b32 v14, v14, v244, v6 bitop3:0xf6
    v_bitop3_b32 v14, v14, v245, v56 bitop3:0xf6
    v_bitop3_b32 v14, v14, v246, v57 bitop3:0xf6
    v_bitop3_b32 v14, v14, v247, v58 bitop3:0xf6
    v_bitop3_b32 v14, v14, v248, v6 bitop3:0xf6
    v_bitop3_b32 v14, v14, v249, v56 bitop3:0xf6
    v_bitop3_b32 v14, v14, v250, v57 bitop3:0xf6
    v_bitop3_b32 v14, v14, v251, v58 bitop3:0xf6
    v_bitop3_b32 v14, v14, v252, v6 bitop3:0xf6
    v_bitop3_b32 v14, v14, v253, v56 bitop3:0xf6
    v_bitop3_b32 v14, v14, v254, v57 bitop3:0xf6
    v_bitop3_b32 v14, v14, v255, v58 bitop3:0xf6
    v_and_b32 v14, 0xff, v14
    v_cmp_ne_u32 vcc, 0, v14
    s_cbranch_vccz L_pd
    s_sleep 24
    s_add_u32 s96, s96, 1
    s_cmp_lt_u32 s96, 0x400000
    s_cbranch_scc1 L_pw
L_pd:
    v_and_b32 v192, 0xffffff00, v192
    v_and_b32 v193, 0xffffff00, v193
    v_and_b32 v194, 0xffffff00, v194
    v_and_b32 v195, 0xffffff00, v195
    v_and_b32 v196, 0xffffff00, v196
    v_and_b32 v197, 0xffffff00, v197
    v_and_b32 v198, 0xffffff00, v198
    v_and_b32 v199, 0xffffff00, v199
    v_and_b32 v200, 0xffffff00, v200
    v_and_b32 v201, 0xffffff00, v201
    v_and_b32 v202, 0xffffff00, v202
    v_and_b32 v203, 0xffffff00, v203
    v_and_b32 v204, 0xffffff00, v204
    v_and_b32 v205, 0xffffff00, v205
    v_and_b32 v206, 0xffffff00, v206
    v_and_b32 v207, 0xffffff00, v207
    v_and_b32 v208, 0xffffff00, v208
    v_and_b32 v209, 0xffffff00, v209
    v_and_b32 v210, 0xffffff00, v210
    v_and_b32 v211, 0xffffff00, v211
    v_and_b32 v212, 0xffffff00, v212
    v_and_b32 v213, 0xffffff00, v213
    v_and_b32 v214, 0xffffff00, v214
    v_and_b32 v215, 0xffffff00, v215
    v_and_b32 v216, 0xffffff00, v216
    v_and_b32 v217, 0xffffff00, v217
    v_and_b32 v218, 0xffffff00, v218
    v_and_b32 v219, 0xffffff00, v219
    v_and_b32 v220, 0xffffff00, v220
    v_and_b32 v221, 0xffffff00, v221
    v_and_b32 v222, 0xffffff00, v222
    v_and_b32 v223, 0xffffff00, v223
    v_and_b32 v224, 0xffffff00, v224
    v_and_b32 v225, 0xffffff00, v225
    v_and_b32 v226, 0xffffff00, v226
    v_and_b32 v227, 0xffffff00, v227
    v_and_b32 v228, 0xffffff00, v228
    v_and_b32 v229, 0xffffff00, v229
    v_and_b32 v230, 0xffffff00, v230
    v_and_b32 v231, 0xffffff00, v231
    v_and_b32 v232, 0xffffff00, v232
    v_and_b32 v233, 0xffffff00, v233
    v_and_b32 v234, 0xffffff00, v234
    v_and_b32 v235, 0xffffff00, v235
    v_and_b32 v236, 0xffffff00, v236
    v_and_b32 v237, 0xffffff00, v237
    v_and_b32 v238, 0xffffff00, v238
    v_and_b32 v239, 0xffffff00, v239
    v_and_b32 v240, 0xffffff00, v240
    v_and_b32 v241, 0xffffff00, v241
    v_and_b32 v242, 0xffffff00, v242
    v_and_b32 v243, 0xffffff00, v243
    v_and_b32 v244, 0xffffff00, v244
    v_and_b32 v245, 0xffffff00, v245
    v_and_b32 v246, 0xffffff00, v246
    v_and_b32 v247, 0xffffff00, v247
    v_and_b32 v248, 0xffffff00, v248
    v_and_b32 v249, 0xffffff00, v249
    v_and_b32 v250, 0xffffff00, v250
    v_and_b32 v251, 0xffffff00, v251
    v_and_b32 v252, 0xffffff00, v252
    v_and_b32 v253, 0xffffff00, v253
    v_and_b32 v254, 0xffffff00, v254
    v_and_b32 v255, 0xffffff00, v255
    v_add_f32 v192, v192, v196
    v_add_f32 v193, v193, v197
    v_add_f32 v194, v194, v198
    v_add_f32 v195, v195, v199
    v_add_f32 v192, v192, v200
    v_add_f32 v193, v193, v201
    v_add_f32 v194, v194, v202
    v_add_f32 v195, v195, v203
    v_add_f32 v192, v192, v204
    v_add_f32 v193, v193, v205
    v_add_f32 v194, v194, v206
    v_add_f32 v195, v195, v207
    v_add_f32 v208, v208, v212
    v_add_f32 v209, v209, v213
    v_add_f32 v210, v210, v214
    v_add_f32 v211, v211, v215
    v_add_f32 v208, v208, v216
    v_add_f32 v209, v209, v217
    v_add_f32 v210, v210, v218
    v_add_f32 v211, v211, v219
    v_add_f32 v208, v208, v220
    v_add_f32 v209, v209, v221
    v_add_f32 v210, v210, v222
    v_add_f32 v211, v211, v223
    v_add_f32 v224, v224, v228
    v_add_f32 v225, v225, v229
    v_add_f32 v226, v226, v230
    v_add_f32 v227, v227, v231
    v_add_f32 v224, v224, v232
    v_add_f32 v225, v225, v233
    v_add_f32 v226, v226, v234
    v_add_f32 v227, v227, v235
    v_add_f32 v224, v224, v236
    v_add_f32 v225, v225, v237
    v_add_f32 v226, v226, v238
    v_add_f32 v227, v227, v239
    v_add_f32 v240, v240, v244
    v_add_f32 v241, v241, v245
    v_add_f32 v242, v242, v246
    v_add_f32 v243, v243, v247
    v_add_f32 v240, v240, v248
    v_add_f32 v241, v241, v249
    v_add_f32 v242, v242, v250
    v_add_f32 v243, v243, v251
    v_add_f32 v240, v240, v252
    v_add_f32 v241, v241, v253
    v_add_f32 v242, v242, v254
    v_add_f32 v243, v243, v255
L_pgskip:
    v_cvt_pk_bf16_f32 v192, v192, v192
    v_and_b32 v192, 0xffff0000, v192
    v_cvt_pk_bf16_f32 v208, v208, v208
    v_and_b32 v208, 0xffff0000, v208
    v_mul_f32 v192, 0xbfb8aa3b, v192
    v_exp_f32 v192, v192
    s_nop 0
    v_add_f32 v192, 1.0, v192
    v_rcp_f32 v192, v192
    s_nop 0
    v_cvt_pk_bf16_f32 v192, v192, v192
    v_and_b32 v192, 0xffff0000, v192
    v_mul_f32 v192, v192, v208
    v_cvt_pk_bf16_f32 v193, v193, v193
    v_and_b32 v193, 0xffff0000, v193
    v_cvt_pk_bf16_f32 v209, v209, v209
    v_and_b32 v209, 0xffff0000, v209
    v_mul_f32 v193, 0xbfb8aa3b, v193
    v_exp_f32 v193, v193
    s_nop 0
    v_add_f32 v193, 1.0, v193
    v_rcp_f32 v193, v193
    s_nop 0
    v_cvt_pk_bf16_f32 v193, v193, v193
    v_and_b32 v193, 0xffff0000, v193
    v_mul_f32 v193, v193, v209
    v_cvt_pk_bf16_f32 v194, v194, v194
    v_and_b32 v194, 0xffff0000, v194
    v_cvt_pk_bf16_f32 v210, v210, v210
    v_and_b32 v210, 0xffff0000, v210
    v_mul_f32 v194, 0xbfb8aa3b, v194
    v_exp_f32 v194, v194
    s_nop 0
    v_add_f32 v194, 1.0, v194
    v_rcp_f32 v194, v194
    s_nop 0
    v_cvt_pk_bf16_f32 v194, v194, v194
    v_and_b32 v194, 0xffff0000, v194
    v_mul_f32 v194, v194, v210
    v_cvt_pk_bf16_f32 v195, v195, v195
    v_and_b32 v195, 0xffff0000, v195
    v_cvt_pk_bf16_f32 v211, v211, v211
    v_and_b32 v211, 0xffff0000, v211
    v_mul_f32 v195, 0xbfb8aa3b, v195
    v_exp_f32 v195, v195
    s_nop 0
    v_add_f32 v195, 1.0, v195
    v_rcp_f32 v195, v195
    s_nop 0
    v_cvt_pk_bf16_f32 v195, v195, v195
    v_and_b32 v195, 0xffff0000, v195
    v_mul_f32 v195, v195, v211
    v_cvt_pk_bf16_f32 v192, v192, v193
    v_cvt_pk_bf16_f32 v193, v194, v195
    v_cvt_pk_bf16_f32 v224, v224, v224
    v_and_b32 v224, 0xffff0000, v224
    v_cvt_pk_bf16_f32 v240, v240, v240
    v_and_b32 v240, 0xffff0000, v240
    v_mul_f32 v224, 0xbfb8aa3b, v224
    v_exp_f32 v224, v224
    s_nop 0
    v_add_f32 v224, 1.0, v224
    v_rcp_f32 v224, v224
    s_nop 0
    v_cvt_pk_bf16_f32 v224, v224, v224
    v_and_b32 v224, 0xffff0000, v224
    v_mul_f32 v224, v224, v240
    v_cvt_pk_bf16_f32 v225, v225, v225
    v_and_b32 v225, 0xffff0000, v225
    v_cvt_pk_bf16_f32 v241, v241, v241
    v_and_b32 v241, 0xffff0000, v241
    v_mul_f32 v225, 0xbfb8aa3b, v225
    v_exp_f32 v225, v225
    s_nop 0
    v_add_f32 v225, 1.0, v225
    v_rcp_f32 v225, v225
    s_nop 0
    v_cvt_pk_bf16_f32 v225, v225, v225
    v_and_b32 v225, 0xffff0000, v225
    v_mul_f32 v225, v225, v241
    v_cvt_pk_bf16_f32 v226, v226, v226
    v_and_b32 v226, 0xffff0000, v226
    v_cvt_pk_bf16_f32 v242, v242, v242
    v_and_b32 v242, 0xffff0000, v242
    v_mul_f32 v226, 0xbfb8aa3b, v226
    v_exp_f32 v226, v226
    s_nop 0
    v_add_f32 v226, 1.0, v226
    v_rcp_f32 v226, v226
    s_nop 0
    v_cvt_pk_bf16_f32 v226, v226, v226
    v_and_b32 v226, 0xffff0000, v226
    v_mul_f32 v226, v226, v242
    v_cvt_pk_bf16_f32 v227, v227, v227
    v_and_b32 v227, 0xffff0000, v227
    v_cvt_pk_bf16_f32 v243, v243, v243
    v_and_b32 v243, 0xffff0000, v243
    v_mul_f32 v227, 0xbfb8aa3b, v227
    v_exp_f32 v227, v227
    s_nop 0
    v_add_f32 v227, 1.0, v227
    v_rcp_f32 v227, v227
    s_nop 0
    v_cvt_pk_bf16_f32 v227, v227, v227
    v_and_b32 v227, 0xffff0000, v227
    v_mul_f32 v227, v227, v243
    v_cvt_pk_bf16_f32 v224, v224, v225
    v_cvt_pk_bf16_f32 v225, v226, v227
    v_cndmask_b32 v224, v224, 0, s[86:87]
    v_cndmask_b32 v225, v225, 0, s[86:87]
    v_lshlrev_b32 v12, 8, v2
    v_lshl_add_u32 v12, v3, 3, v12
    ds_write_b64 v12, v[192:193] offset:9216
    ds_write_b64 v12, v[224:225] offset:9344
L_s2_end:
    s_lshr_b32 s97, s31, 3
    s_lshl_b32 s22, s97, 10
    s_lshl_b32 s97, s30, 8
    s_add_u32 s22, s22, s97
    s_and_b32 s97, s31, 7
    s_lshl_b32 s97, s97, 5
    s_add_u32 s22, s22, s97
    s_add_u32 s19, s22, 970752
    s_add_u32 s22, s22, 4096
    s_lshl_b32 s97, s30, 10
    buffer_load_dwordx4 v[24:27], v5, s[48:51], s97 offen
    buffer_load_dwordx4 v[28:31], v5, s[60:63], 0 offen
    s_waitcnt vmcnt(0)
    v_mov_b32 v0, 0
    v_lshlrev_b32 v12, 16, v24
    v_lshlrev_b32 v13, 16, v28
    v_and_b32 v14, 0xffff0000, v24
    v_and_b32 v15, 0xffff0000, v28
    v_mul_f32 v12, v12, v13
    v_mul_f32 v14, v14, v15
    v_cvt_pk_bf16_f32 v12, v12, v14
    v_lshlrev_b32 v13, 16, v12
    v_and_b32 v14, 0xffff0000, v12
    v_add_f32 v0, v0, v13
    v_add_f32 v0, v0, v14
    v_lshlrev_b32 v12, 16, v25
    v_lshlrev_b32 v13, 16, v29
    v_and_b32 v14, 0xffff0000, v25
    v_and_b32 v15, 0xffff0000, v29
    v_mul_f32 v12, v12, v13
    v_mul_f32 v14, v14, v15
    v_cvt_pk_bf16_f32 v12, v12, v14
    v_lshlrev_b32 v13, 16, v12
    v_and_b32 v14, 0xffff0000, v12
    v_add_f32 v0, v0, v13
    v_add_f32 v0, v0, v14
    v_lshlrev_b32 v12, 16, v26
    v_lshlrev_b32 v13, 16, v30
    v_and_b32 v14, 0xffff0000, v26
    v_and_b32 v15, 0xffff0000, v30
    v_mul_f32 v12, v12, v13
    v_mul_f32 v14, v14, v15
    v_cvt_pk_bf16_f32 v12, v12, v14
    v_lshlrev_b32 v13, 16, v12
    v_and_b32 v14, 0xffff0000, v12
    v_add_f32 v0, v0, v13
    v_add_f32 v0, v0, v14
    v_lshlrev_b32 v12, 16, v27
    v_lshlrev_b32 v13, 16, v31
    v_and_b32 v14, 0xffff0000, v27
    v_and_b32 v15, 0xffff0000, v31
    v_mul_f32 v12, v12, v13
    v_mul_f32 v14, v14, v15
    v_cvt_pk_bf16_f32 v12, v12, v14
    v_lshlrev_b32 v13, 16, v12
    v_and_b32 v14, 0xffff0000, v12
    v_add_f32 v0, v0, v13
    v_add_f32 v0, v0, v14
    s_nop 1
    v_add_f32_dpp v12, v0, v0 quad_perm:[1,0,3,2] row_mask:0xf bank_mask:0xf
    s_nop 1
    v_add_f32_dpp v0, v12, v12 quad_perm:[2,3,0,1] row_mask:0xf bank_mask:0xf
    s_nop 1
    v_add_f32_dpp v12, v0, v0 row_ror:4 row_mask:0xf bank_mask:0xf
    s_nop 1
    v_add_f32_dpp v0, v12, v12 row_ror:8 row_mask:0xf bank_mask:0xf
    s_nop 0
    v_readlane_b32 s97, v0, 0
    v_readlane_b32 s98, v0, 16
    v_readlane_b32 s99, v0, 32
    v_readlane_b32 s100, v0, 48
    s_nop 1
    v_mov_b32 v0, s97
    v_add_f32 v0, s98, v0
    v_add_f32 v0, s99, v0
    v_add_f32 v0, s100, v0
    v_cvt_pk_bf16_f32 v0, v0, v0
    v_and_b32 v0, 0xffff0000, v0
    v_mul_f32 v0, 0xbfb8aa3b, v0
    v_exp_f32 v0, v0
    s_nop 0
    v_add_f32 v0, 1.0, v0
    v_rcp_f32 v0, v0
    s_nop 0
    v_cvt_pk_bf16_f32 v0, v0, v0
    v_and_b32 v0, 0xffff0000, v0
    v_sub_f32 v61, 1.0, v0
    v_cvt_pk_bf16_f32 v61, v61, v61
    v_and_b32 v61, 0xffff0000, v61
    v_and_b32 v12, 3, v3
    v_lshlrev_b32 v12, 8, v12
    v_lshl_add_u32 v12, v2, 4, v12
    ds_read_b128 v[20:23], v12 offset:9216
    ds_read_b128 v[24:27], v12 offset:9280
    ds_read_b128 v[28:31], v12 offset:9344
    ds_read_b128 v[32:35], v12 offset:9408
    s_sub_u32 s74, s3, 168
    s_lshl_b32 s74, s74, 10
    s_add_u32 s74, s74, 970752
    v_mov_b32 v12, 0
L_wt:
    ds_read_b32 v13, v12 offset:8264
    s_waitcnt lgkmcnt(0)
    v_readfirstlane_b32 s97, v13
    s_cmp_lg_u32 s97, 0
    s_cbranch_scc1 L_wtd
    s_sleep 2
    s_branch L_wt
L_wtd:
    s_lshl_b32 s94, s18, 17
    s_lshl_b32 s97, s24, 7
    s_add_u32 s94, s94, s97
    s_movk_i32 s97, 1024
    v_mad_u32_u24 v54, v60, s97, v52
    v_mad_u32_u24 v55, v60, s97, v53
    s_mov_b32 m0, 49152
    s_nop 0
    buffer_load_dwordx4 v54, s[44:47], s94 offen nt lds
    s_mov_b32 m0, 50176
    s_add_u32 s94, s94, 8192
    buffer_load_dwordx4 v55, s[44:47], s94 offen nt lds
    s_mov_b32 m0, 51200
    s_add_u32 s94, s94, 8192
    buffer_load_dwordx4 v54, s[44:47], s94 offen nt lds
    s_mov_b32 m0, 52224
    s_add_u32 s94, s94, 8192
    buffer_load_dwordx4 v55, s[44:47], s94 offen nt lds
    s_mov_b32 m0, 53248
    s_add_u32 s94, s94, 8192
    buffer_load_dwordx4 v54, s[44:47], s94 offen nt lds
    s_mov_b32 m0, 54272
    s_add_u32 s94, s94, 8192
    buffer_load_dwordx4 v55, s[44:47], s94 offen nt lds
    s_mov_b32 m0, 55296
    s_add_u32 s94, s94, 8192
    buffer_load_dwordx4 v54, s[44:47], s94 offen nt lds
    s_mov_b32 m0, 56320
    s_add_u32 s94, s94, 8192
    buffer_load_dwordx4 v55, s[44:47], s94 offen nt lds
    s_mov_b32 m0, 57344
    s_add_u32 s94, s94, 8192
    buffer_load_dwordx4 v54, s[44:47], s94 offen nt lds
    s_mov_b32 m0, 58368
    s_add_u32 s94, s94, 8192
    buffer_load_dwordx4 v55, s[44:47], s94 offen nt lds
    s_mov_b32 m0, 59392
    s_add_u32 s94, s94, 8192
    buffer_load_dwordx4 v54, s[44:47], s94 offen nt lds
    s_mov_b32 m0, 60416
    s_add_u32 s94, s94, 8192
    buffer_load_dwordx4 v55, s[44:47], s94 offen nt lds
    s_mov_b32 m0, 61440
    s_add_u32 s94, s94, 8192
    buffer_load_dwordx4 v54, s[44:47], s94 offen nt lds
    s_mov_b32 m0, 62464
    s_add_u32 s94, s94, 8192
    buffer_load_dwordx4 v55, s[44:47], s94 offen nt lds
    s_mov_b32 m0, 63488
    s_add_u32 s94, s94, 8192
    buffer_load_dwordx4 v54, s[44:47], s94 offen nt lds
    s_mov_b32 m0, 64512
    s_add_u32 s94, s94, 8192
    buffer_load_dwordx4 v55, s[44:47], s94 offen nt lds
    s_cmp_lt_u32 s3, 168
    s_cbranch_scc1 L_nowd
    s_sub_u32 s99, s3, 168
    s_and_b32 s98, s99, 7
    s_lshr_b32 s99, s99, 3
    s_lshl_b32 s98, s98, 7
    s_lshl_b32 s94, s99, 17
    s_add_u32 s94, s94, s98
    s_add_u32 s100, s98, 1400832
    s_movk_i32 s97, 1024
    v_mad_u32_u24 v54, v60, s97, v52
    v_mad_u32_u24 v55, v60, s97, v53
    s_mov_b32 m0, 32768
    s_nop 0
    buffer_load_dwordx4 v54, s[76:79], s94 offen nt lds
    s_mov_b32 m0, 33792
    s_add_u32 s94, s94, 8192
    buffer_load_dwordx4 v55, s[76:79], s94 offen nt lds
    s_mov_b32 m0, 34816
    s_add_u32 s94, s94, 8192
    buffer_load_dwordx4 v54, s[76:79], s94 offen nt lds
    s_mov_b32 m0, 35840
    s_add_u32 s94, s94, 8192
    buffer_load_dwordx4 v55, s[76:79], s94 offen nt lds
    s_mov_b32 m0, 36864
    s_add_u32 s94, s94, 8192
    buffer_load_dwordx4 v54, s[76:79], s94 offen nt lds
    s_mov_b32 m0, 37888
    s_add_u32 s94, s94, 8192
    buffer_load_dwordx4 v55, s[76:79], s94 offen nt lds
    s_mov_b32 m0, 38912
    s_add_u32 s94, s94, 8192
    buffer_load_dwordx4 v54, s[76:79], s94 offen nt lds
    s_mov_b32 m0, 39936
    s_add_u32 s94, s94, 8192
    buffer_load_dwordx4 v55, s[76:79], s94 offen nt lds
    s_mov_b32 m0, 40960
    s_add_u32 s94, s94, 8192
    buffer_load_dwordx4 v54, s[76:79], s94 offen nt lds
    s_mov_b32 m0, 41984
    s_add_u32 s94, s94, 8192
    buffer_load_dwordx4 v55, s[76:79], s94 offen nt lds
    s_mov_b32 m0, 43008
    s_add_u32 s94, s94, 8192
    buffer_load_dwordx4 v54, s[76:79], s94 offen nt lds
    s_mov_b32 m0, 44032
    s_add_u32 s94, s94, 8192
    buffer_load_dwordx4 v55, s[76:79], s94 offen nt lds
    s_mov_b32 m0, 45056
    s_add_u32 s94, s94, 8192
    s_min_u32 s94, s94, s100
    buffer_load_dwordx4 v54, s[76:79], s94 offen nt lds
    s_mov_b32 m0, 46080
    s_add_u32 s94, s94, 8192
    s_min_u32 s94, s94, s100
    buffer_load_dwordx4 v55, s[76:79], s94 offen nt lds
    s_mov_b32 m0, 47104
    s_add_u32 s94, s94, 8192
    s_min_u32 s94, s94, s100
    buffer_load_dwordx4 v54, s[76:79], s94 offen nt lds
    s_mov_b32 m0, 48128
    s_add_u32 s94, s94, 8192
    s_min_u32 s94, s94, s100
    buffer_load_dwordx4 v55, s[76:79], s94 offen nt lds
L_nowd:
    s_branch L_ogather
L_codeend:
.section .rodata,"a"
.p2align 6
.amdhsa_kernel gated_mix__gqa_block_cached__glu_gated_glu__decode_kernel
  .amdhsa_next_free_vgpr 256
  .amdhsa_next_free_sgpr 102
  .amdhsa_accum_offset 256
  .amdhsa_group_segment_fixed_size 0
  .amdhsa_kernarg_size 104
  .amdhsa_user_sgpr_count 2
  .amdhsa_user_sgpr_kernarg_segment_ptr 1
  .amdhsa_system_sgpr_workgroup_id_x 1
.end_amdhsa_kernel
```
